```python
import torch

def _softmax(x, axis=-1):
    return torch.softmax(x, dim=axis)
def _gelu(x):
    return torch.nn.functional.gelu(x, approximate="tanh")
def _silu(x):
    return torch.nn.functional.silu(x)
def _sigmoid(x):
    return torch.sigmoid(x)
def _layernorm(x, axis=-1, eps=1e-5):
    m = x.mean(dim=axis, keepdim=True)
    v = x.var(dim=axis, keepdim=True, unbiased=False)
    return (x - m) / torch.sqrt(v + eps)
def _scatter_add(tgt, idx, src, axis=0):
    return tgt.clone().index_add_(axis, idx, src)
def _segment_sum(src, seg, n):
    out = torch.zeros((n,) + src.shape[1:], dtype=src.dtype)
    return out.index_add_(0, seg, src)
def _pad(x, pw):
    flat = tuple(v for pair in reversed(pw) for v in pair)
    return torch.nn.functional.pad(x, flat)

kernel_name = 'standalone__gqa_softmax__sampling'

def setup_inputs():

    _w = (lambda a: (lambda t: t.to(torch.bfloat16) if t.is_floating_point() else t)(torch.as_tensor(a)))
    B, Hq, Hkv, Sq, Sk, D = 16, 32, 16, 4, 4096, 128
    return {
        "q": _w((lambda *s: torch.randn(*s, dtype=torch.bfloat16) * 0.8)(B, Hq, Sq, D)),
        "k": _w((lambda *s: torch.randn(*s, dtype=torch.bfloat16) * 0.8)(B, Hkv, Sk, D)),
        "v": _w((lambda *s: torch.randn(*s, dtype=torch.bfloat16) * 0.05)(B, Hkv, Sk, D)),
    }

def reference(q, k, v):
    B, Hq, Sq, D = q.shape
    Hkv = k.shape[1]
    rep = Hq // Hkv
    k = (lambda x, n, axis: torch.repeat_interleave(x, n, dim=axis))(k, rep, axis=1)
    v = (lambda x, n, axis: torch.repeat_interleave(x, n, dim=axis))(v, rep, axis=1)
    scale = D ** -0.5
    scores = torch.einsum("bhqd,bhkd->bhqk", q, k) * scale
    p = _softmax(scores, axis=-1)
    return torch.einsum("bhqk,bhkd->bhqd", p, v)
```

```asm
; @launch grid=(256,1,1) block=(128,1,1) lds=139264
.amdgcn_target "amdgcn-amd-amdhsa--gfx950"
.text
.globl standalone__gqa_softmax__sampling_kernel
.p2align 8
.type standalone__gqa_softmax__sampling_kernel,@function
standalone__gqa_softmax__sampling_kernel:
    s_cmp_ge_u32 s2, 256
    s_cbranch_scc1 L_end
    s_load_dwordx4 s[4:7], s[0:1], 0
    s_load_dwordx4 s[36:39], s[0:1], 16
    s_load_dwordx2 s[48:49], s[0:1], 40
    v_lshrrev_b32 v3, 6, v0
    v_and_b32 v0, 63, v0
    v_readfirstlane_b32 s27, v3
    v_lshrrev_b32 v3, 4, v0
    v_lshlrev_b32 v3, 6, v3
    v_and_b32 v4, 3, v0
    v_lshl_add_u32 v1, v4, 4, v3
    v_bfe_i32 v4, v0, 2, 1
    v_and_b32 v4, 0xa00, v4
    v_xor_b32 v1, v1, v4
    v_bfe_i32 v4, v0, 3, 1
    v_and_b32 v4, 0x1b000, v4
    v_xor_b32 v1, v1, v4
    v_and_b32 v4, 7, v0
    v_lshl_add_u32 v3, v4, 8, v3
    v_bfe_u32 v4, v0, 3, 1
    v_lshl_add_u32 v3, v4, 4, v3
    v_cmp_ne_u32 s[34:35], 0, v4
    s_mov_b32 s24, 0
    s_bitcmp1_b32 s27, 0
    s_cselect_b32 s3, 0x1e000, 0
    s_xor_b32 s24, s24, s3
    s_bitcmp1_b32 s2, 0
    s_cselect_b32 s3, 0x70000, 0
    s_xor_b32 s24, s24, s3
    s_bitcmp1_b32 s2, 1
    s_cselect_b32 s3, 0x18800, 0
    s_xor_b32 s24, s24, s3
    s_bitcmp1_b32 s2, 2
    s_cselect_b32 s3, 0xac000, 0
    s_xor_b32 s24, s24, s3
    s_bitcmp1_b32 s2, 3
    s_cselect_b32 s3, 0x6800, 0
    s_xor_b32 s24, s24, s3
    s_bitcmp1_b32 s2, 4
    s_cselect_b32 s3, 0x95800, 0
    s_xor_b32 s24, s24, s3
    s_bitcmp1_b32 s2, 5
    s_cselect_b32 s3, 0x48000, 0
    s_xor_b32 s24, s24, s3
    s_bitcmp1_b32 s2, 6
    s_cselect_b32 s3, 0xb000, 0
    s_xor_b32 s24, s24, s3
    s_bitcmp1_b32 s2, 7
    s_cselect_b32 s3, 0x69000, 0
    s_xor_b32 s24, s24, s3
    s_getreg_b32 s3, hwreg(HW_REG_XCC_ID)
    s_xor_b32 s3, s3, s2
    s_bitcmp1_b32 s3, 2
    s_cselect_b32 s3, 0x43f00, 0
    s_xor_b32 s24, s24, s3
    v_xor_b32 v178, s24, v1
    s_getpc_b64 s[62:63]
L_pc:
    s_lshr_b32 s3, s2, 3
    s_lshl_b32 s3, s3, 1
    s_add_u32 s3, s3, s27
    s_lshl_b32 s3, s3, 9
    v_lshl_add_u32 v184, v0, 3, s3
    v_min_u32 v184, L_last-L_pc-8, v184
    v_mov_b32 v185, s63
    v_add_co_u32 v184, vcc, s62, v184
    s_nop 1
    v_addc_co_u32 v185, vcc, 0, v185, vcc
    global_load_dword v189, v[184:185], off
    s_lshl_b32 s31, s2, 20
    s_lshl_b32 s3, s2, 11
    s_mov_b32 s10, 0x100000
    s_mov_b32 s11, 0x20000
    s_mov_b32 s18, 0x800
    s_mov_b32 s19, 0x20000
    s_mov_b32 s22, 0x800
    s_mov_b32 s23, 0x20000
    s_waitcnt lgkmcnt(0)
    s_add_u32 s8, s6, s31
    s_addc_u32 s9, s7, 0
    buffer_load_dwordx4 v[112:115], v178, s[8:11], 0 offen nt
    v_xor_b32 v180, 0x8b00, v178
    buffer_load_dwordx4 v[116:119], v180, s[8:11], 0 offen nt
    s_add_u32 s16, s4, s3
    s_addc_u32 s17, s5, 0
    buffer_load_dwordx4 v[16:19], v3, s[16:19], 0 offen
    buffer_load_dwordx4 v[20:23], v3, s[16:19], 0 offen offset:32
    v_xor_b32 v179, 0x12000, v178
    buffer_load_dwordx4 v[120:123], v179, s[8:11], 0 offen nt
    v_xor_b32 v180, 0x1ab00, v178
    buffer_load_dwordx4 v[124:127], v180, s[8:11], 0 offen nt
    v_xor_b32 v179, 0x72b00, v178
    buffer_load_dwordx4 v[128:131], v179, s[8:11], 0 offen nt
    v_xor_b32 v180, 0x7a000, v178
    buffer_load_dwordx4 v[132:135], v180, s[8:11], 0 offen nt
    v_xor_b32 v179, 0x60b00, v178
    buffer_load_dwordx4 v[136:139], v179, s[8:11], 0 offen nt
    v_xor_b32 v180, 0x68000, v178
    buffer_load_dwordx4 v[140:143], v180, s[8:11], 0 offen nt
    v_xor_b32 v179, 0x8800, v178
    buffer_load_dwordx4 v[144:147], v179, s[8:11], 0 offen nt
    v_xor_b32 v180, 0x300, v178
    buffer_load_dwordx4 v[148:151], v180, s[8:11], 0 offen nt
    s_add_u32 s12, s36, s31
    s_addc_u32 s13, s37, 0
    s_add_u32 s20, s38, s3
    s_addc_u32 s21, s39, 0
    s_and_b32 s31, s2, 7
    s_mul_i32 s31, s31, 0
    s_lshr_b32 s3, s2, 3
    s_xor_b32 s3, s3, s31
    s_and_b32 s3, s3, 31
    s_lshl_b32 s31, s27, 5
    s_or_b32 s3, s3, s31
    s_mul_i32 s3, s3, 256
    s_add_u32 s82, s3, 0x0
    s_load_dword s83, s[48:49], s82 glc
    s_and_b32 s31, s2, 7
    s_mul_i32 s31, s31, 1
    s_lshr_b32 s3, s2, 3
    s_xor_b32 s3, s3, s31
    s_and_b32 s3, s3, 31
    s_lshl_b32 s31, s27, 5
    s_or_b32 s3, s3, s31
    s_mul_i32 s3, s3, 256
    s_add_u32 s84, s3, 0x4000
    s_load_dword s85, s[48:49], s84 glc
    s_and_b32 s31, s2, 7
    s_mul_i32 s31, s31, 4
    s_lshr_b32 s3, s2, 3
    s_xor_b32 s3, s3, s31
    s_and_b32 s3, s3, 31
    s_lshl_b32 s31, s27, 5
    s_or_b32 s3, s3, s31
    s_mul_i32 s3, s3, 256
    s_add_u32 s86, s3, 0x8000
    s_load_dword s87, s[48:49], s86 glc
    s_and_b32 s31, s2, 7
    s_mul_i32 s31, s31, 3
    s_lshr_b32 s3, s2, 3
    s_xor_b32 s3, s3, s31
    s_and_b32 s3, s3, 31
    s_lshl_b32 s31, s27, 5
    s_or_b32 s3, s3, s31
    s_mul_i32 s3, s3, 256
    s_add_u32 s88, s3, 0xc000
    s_load_dword s89, s[48:49], s88 glc
    s_mov_b32 s50, 24
    s_mov_b32 s57, 0
    s_mov_b32 s51, 0
    s_mov_b32 s52, 10
    s_mov_b32 s28, 0x3e0293ee
    s_mov_b32 s29, 0x05040100
    s_mov_b32 s30, 0x07060302
    s_mov_b32 s33, 0
    s_xor_b32 s25, s24, 0x11300
    s_mov_b32 s26, 32
    v_and_b32 v2, 15, v0
    v_lshlrev_b32 v2, 4, v2
    v_bfe_i32 v4, v0, 4, 1
    v_and_b32 v4, 0xa00, v4
    v_xor_b32 v2, v2, v4
    v_bfe_i32 v4, v0, 5, 1
    v_and_b32 v4, 0x1b000, v4
    v_xor_b32 v2, v2, v4
    s_lshl_b32 s31, s27, 16
    v_lshl_add_u32 v7, v0, 4, s31
    v_mov_b32 v5, 0xff800000
    v_mov_b32 v6, 0
    v_mov_b32 v80, 0
    v_mov_b32 v81, 0
    v_mov_b32 v82, 0
    v_mov_b32 v83, 0
    v_mov_b32 v84, 0
    v_mov_b32 v85, 0
    v_mov_b32 v86, 0
    v_mov_b32 v87, 0
    v_mov_b32 v88, 0
    v_mov_b32 v89, 0
    v_mov_b32 v90, 0
    v_mov_b32 v91, 0
    v_mov_b32 v92, 0
    v_mov_b32 v93, 0
    v_mov_b32 v94, 0
    v_mov_b32 v95, 0
    v_mov_b32 v96, 0
    v_mov_b32 v97, 0
    v_mov_b32 v98, 0
    v_mov_b32 v99, 0
    v_mov_b32 v100, 0
    v_mov_b32 v101, 0
    v_mov_b32 v102, 0
    v_mov_b32 v103, 0
    v_mov_b32 v104, 0
    v_mov_b32 v105, 0
    v_mov_b32 v106, 0
    v_mov_b32 v107, 0
    v_mov_b32 v108, 0
    v_mov_b32 v109, 0
    v_mov_b32 v110, 0
    v_mov_b32 v111, 0
    s_lshl_b32 s3, s27, 11
    s_add_u32 s3, s3, 135168
    v_lshl_add_u32 v181, v0, 4, s3
    v_xor_b32 v184, 0x800, v181
    v_and_b32 v3, 7, v0
    s_lshl_b32 s3, s27, 6
    s_add_u32 s3, s3, 133120
    v_lshl_add_u32 v182, v3, 3, s3
    v_xor_b32 v183, 64, v182
    v_lshrrev_b32 v4, 4, v0
    v_lshlrev_b32 v4, 6, v4
    v_lshl_add_u32 v188, v3, 8, v4
    v_bfe_u32 v4, v0, 3, 1
    v_lshl_add_u32 v188, v4, 4, v188
    s_lshl_b32 s3, s27, 5
    v_add_u32 v188, s3, v188
    s_waitcnt vmcnt(8)
.p2align 3
L_K10:
    v_xor_b32 v179, 0x1a800, v178
    s_waitcnt vmcnt(9)
    buffer_load_dwordx4 v[152:155], v179, s[8:11], 0 offen nt
L_K10_a:
    v_xor_b32 v180, 0x12300, v178
    buffer_load_dwordx4 v[156:159], v180, s[8:11], 0 offen nt
    s_add_u32 s33, s33, 1
    v_mfma_f32_16x16x32_bf16 v[32:35], v[112:115], v[16:19], 0
    v_mfma_f32_16x16x32_bf16 v[36:39], v[112:115], v[20:23], 0
    v_xor_b32 v179, 0x7a300, v178
    s_waitcnt vmcnt(10)
    buffer_load_dwordx4 v[160:163], v179, s[8:11], 0 offen nt
    v_mfma_f32_16x16x32_bf16 v[40:43], v[116:119], v[16:19], 0
    v_mfma_f32_16x16x32_bf16 v[44:47], v[116:119], v[20:23], 0
    s_nop 2
    v_add_f32 v8, v32, v38
    v_add_f32 v9, v33, v39
    v_xor_b32 v180, 0x72800, v178
    s_waitcnt vmcnt(10)
    buffer_load_dwordx4 v[164:167], v180, s[8:11], 0 offen nt
    v_mfma_f32_16x16x32_bf16 v[32:35], v[120:123], v[16:19], 0
    v_mfma_f32_16x16x32_bf16 v[36:39], v[120:123], v[20:23], 0
    v_add_f32_dpp v24, v9, v8 row_ror:8 row_mask:0xf bank_mask:0x3
    v_add_f32 v10, v40, v46
    v_add_f32 v11, v41, v47
    v_xor_b32 v179, 0x68300, v178
    s_waitcnt vmcnt(10)
    buffer_load_dwordx4 v[168:171], v179, s[8:11], 0 offen nt
    v_mfma_f32_16x16x32_bf16 v[40:43], v[124:127], v[16:19], 0
    v_mfma_f32_16x16x32_bf16 v[44:47], v[124:127], v[20:23], 0
    v_add_f32_dpp v25, v11, v10 row_ror:8 row_mask:0xf bank_mask:0x3
    v_add_f32 v8, v32, v38
    v_add_f32 v9, v33, v39
    s_waitcnt vmcnt(10)
    v_mfma_f32_16x16x32_bf16 v[32:35], v[128:131], v[16:19], 0
    v_mfma_f32_16x16x32_bf16 v[36:39], v[128:131], v[20:23], 0
    v_add_f32_dpp v26, v9, v8 row_ror:8 row_mask:0xf bank_mask:0x3
    s_nop 0
    v_add_f32 v10, v40, v46
    v_add_f32 v11, v41, v47
    v_xor_b32 v180, 0x60800, v178
    s_waitcnt vmcnt(9)
    buffer_load_dwordx4 v[172:175], v180, s[8:11], 0 offen nt
    v_mfma_f32_16x16x32_bf16 v[40:43], v[132:135], v[16:19], 0
    v_mfma_f32_16x16x32_bf16 v[44:47], v[132:135], v[20:23], 0
    v_add_f32_dpp v27, v11, v10 row_ror:8 row_mask:0xf bank_mask:0x3
    v_add_f32 v8, v32, v38
    v_add_f32 v9, v33, v39
    s_cmp_eq_u32 s26, 1
    s_cselect_b32 s8, s12, s8
    s_cselect_b32 s9, s13, s9
    s_cselect_b64 vcc, -1, 0
    v_cndmask_b32 v1, v1, v2, vcc
    v_xor_b32 v178, s25, v1
    s_waitcnt vmcnt(9)
    buffer_load_dwordx4 v[112:115], v178, s[8:11], 0 offen nt
    v_mfma_f32_16x16x32_bf16 v[32:35], v[136:139], v[16:19], 0
    v_mfma_f32_16x16x32_bf16 v[36:39], v[136:139], v[20:23], 0
    v_add_f32_dpp v28, v9, v8 row_ror:8 row_mask:0xf bank_mask:0x3
    v_add_f32 v10, v40, v46
    v_add_f32 v11, v41, v47
    v_xor_b32 v180, 0x8b00, v178
    s_waitcnt vmcnt(9)
    buffer_load_dwordx4 v[116:119], v180, s[8:11], 0 offen nt
    v_mfma_f32_16x16x32_bf16 v[40:43], v[140:143], v[16:19], 0
    v_mfma_f32_16x16x32_bf16 v[44:47], v[140:143], v[20:23], 0
    v_add_f32_dpp v29, v11, v10 row_ror:8 row_mask:0xf bank_mask:0x3
    v_add_f32 v8, v32, v38
    v_add_f32 v9, v33, v39
    v_xor_b32 v179, 0x12000, v178
    s_waitcnt vmcnt(9)
    buffer_load_dwordx4 v[120:123], v179, s[8:11], 0 offen nt
    v_mfma_f32_16x16x32_bf16 v[32:35], v[144:147], v[16:19], 0
    v_mfma_f32_16x16x32_bf16 v[36:39], v[144:147], v[20:23], 0
    v_add_f32_dpp v30, v9, v8 row_ror:8 row_mask:0xf bank_mask:0x3
    v_add_f32 v10, v40, v46
    v_add_f32 v11, v41, v47
    v_xor_b32 v180, 0x1ab00, v178
    s_waitcnt vmcnt(9)
    buffer_load_dwordx4 v[124:127], v180, s[8:11], 0 offen nt
    v_mfma_f32_16x16x32_bf16 v[40:43], v[148:151], v[16:19], 0
    v_mfma_f32_16x16x32_bf16 v[44:47], v[148:151], v[20:23], 0
    v_add_f32_dpp v31, v11, v10 row_ror:8 row_mask:0xf bank_mask:0x3
    v_add_f32 v8, v32, v38
    v_add_f32 v9, v33, v39
    v_xor_b32 v179, 0x72b00, v178
    s_waitcnt vmcnt(9)
    buffer_load_dwordx4 v[128:131], v179, s[8:11], 0 offen nt
    v_mfma_f32_16x16x32_bf16 v[32:35], v[152:155], v[16:19], 0
    v_mfma_f32_16x16x32_bf16 v[36:39], v[152:155], v[20:23], 0
    v_add_f32_dpp v24, v8, v9 row_ror:8 row_mask:0xf bank_mask:0xc
    v_add_f32 v10, v40, v46
    v_add_f32 v11, v41, v47
    v_xor_b32 v180, 0x7a000, v178
    s_waitcnt vmcnt(9)
    buffer_load_dwordx4 v[132:135], v180, s[8:11], 0 offen nt
    v_mfma_f32_16x16x32_bf16 v[40:43], v[156:159], v[16:19], 0
    v_mfma_f32_16x16x32_bf16 v[44:47], v[156:159], v[20:23], 0
    v_add_f32_dpp v25, v10, v11 row_ror:8 row_mask:0xf bank_mask:0xc
    v_add_f32 v8, v32, v38
    v_add_f32 v9, v33, v39
    s_add_u32 s31, s33, 1
    s_mov_b32 s25, s24
    s_bitcmp1_b32 s31, 0
    s_cselect_b32 s3, 0x11300, 0
    s_xor_b32 s25, s25, s3
    s_bitcmp1_b32 s31, 1
    s_cselect_b32 s3, 0xc9200, 0
    s_xor_b32 s25, s25, s3
    s_bitcmp1_b32 s31, 2
    s_cselect_b32 s3, 0x4b000, 0
    s_xor_b32 s25, s25, s3
    s_bitcmp1_b32 s31, 3
    s_cselect_b32 s3, 0x94100, 0
    s_xor_b32 s25, s25, s3
    s_bitcmp1_b32 s31, 4
    s_cselect_b32 s3, 0x43f00, 0
    s_xor_b32 s25, s25, s3
    v_xor_b32 v179, 0x60b00, v178
    s_waitcnt vmcnt(9)
    buffer_load_dwordx4 v[136:139], v179, s[8:11], 0 offen nt
    v_mfma_f32_16x16x32_bf16 v[32:35], v[160:163], v[16:19], 0
    v_mfma_f32_16x16x32_bf16 v[36:39], v[160:163], v[20:23], 0
    v_add_f32_dpp v26, v8, v9 row_ror:8 row_mask:0xf bank_mask:0xc
    v_add_f32 v10, v40, v46
    v_add_f32 v11, v41, v47
    s_sub_u32 s26, s26, 1
    s_cmp_lt_u32 s33, s51
    s_cselect_b32 s60, s52, 10
    s_xor_b32 s60, s60, 10
    s_cmp_eq_u32 s26, 0
    s_cselect_b32 s60, 1, s60
    s_cmp_eq_u32 s33, s50
    s_cselect_b32 s60, 1, s60
    v_xor_b32 v180, 0x68000, v178
    s_waitcnt vmcnt(9)
    buffer_load_dwordx4 v[140:143], v180, s[8:11], 0 offen nt
    v_mfma_f32_16x16x32_bf16 v[40:43], v[164:167], v[16:19], 0
    v_mfma_f32_16x16x32_bf16 v[44:47], v[164:167], v[20:23], 0
    v_add_f32_dpp v27, v10, v11 row_ror:8 row_mask:0xf bank_mask:0xc
    v_add_f32 v8, v32, v38
    v_add_f32 v9, v33, v39
    v_xor_b32 v179, 0x8800, v178
    s_waitcnt vmcnt(9)
    buffer_load_dwordx4 v[144:147], v179, s[8:11], 0 offen nt
    v_mfma_f32_16x16x32_bf16 v[32:35], v[168:171], v[16:19], 0
    v_mfma_f32_16x16x32_bf16 v[36:39], v[168:171], v[20:23], 0
    v_add_f32_dpp v28, v8, v9 row_ror:8 row_mask:0xf bank_mask:0xc
    v_add_f32 v10, v40, v46
    v_add_f32 v11, v41, v47
    v_xor_b32 v180, 0x300, v178
    s_waitcnt vmcnt(9)
    buffer_load_dwordx4 v[148:151], v180, s[8:11], 0 offen nt
    v_mfma_f32_16x16x32_bf16 v[40:43], v[172:175], v[16:19], 0
    v_mfma_f32_16x16x32_bf16 v[44:47], v[172:175], v[20:23], 0
    v_add_f32_dpp v29, v10, v11 row_ror:8 row_mask:0xf bank_mask:0xc
    v_add_f32 v8, v32, v38
    v_add_f32 v9, v33, v39
    s_nop 1
    v_add_f32_dpp v30, v8, v9 row_ror:8 row_mask:0xf bank_mask:0xc
    s_nop 1
    v_add_f32 v10, v40, v46
    v_add_f32 v11, v41, v47
    v_max3_f32 v5, v5, v24, v25
    v_max3_f32 v5, v5, v26, v27
    v_add_f32_dpp v31, v10, v11 row_ror:8 row_mask:0xf bank_mask:0xc
    ds_write_b128 v7, v[24:27]
    v_max3_f32 v5, v5, v28, v29
    v_max3_f32 v5, v5, v30, v31
    ds_write_b128 v7, v[28:31] offset:1024
    v_add_u32 v7, 2048, v7
    s_cmp_eq_u32 s60, 0
    s_cbranch_scc1 L_K10
    s_cmp_eq_u32 s26, 0
    s_cmp_lg_u32 s33, s50
    s_cbranch_scc1 L_K10_c
    s_call_b64 s[58:59], L_ctl
L_K10_c:
    s_cmp_eq_u32 s26, 0
    s_cbranch_scc1 L_T10
    s_cmp_lt_u32 s33, s51
    s_cselect_b32 s32, s52, 10
    s_cmp_gt_u32 s32, 10
    s_cbranch_scc1 L_K10_up
    s_cmp_ge_u32 s32, 10
    s_cbranch_scc1 L_K10
    s_waitcnt vmcnt(9)
    s_branch L_K9_a
L_K10_up:
    v_xor_b32 v179, 0x1a800, v178
    buffer_load_dwordx4 v[152:155], v179, s[8:11], 0 offen nt
    s_branch L_K11
.p2align 3
L_K8:
    v_xor_b32 v179, 0x8800, v178
    s_waitcnt vmcnt(7)
    buffer_load_dwordx4 v[144:147], v179, s[8:11], 0 offen nt
L_K8_a:
    v_xor_b32 v180, 0x300, v178
    buffer_load_dwordx4 v[148:151], v180, s[8:11], 0 offen nt
    s_add_u32 s33, s33, 1
    v_mfma_f32_16x16x32_bf16 v[32:35], v[112:115], v[16:19], 0
    v_mfma_f32_16x16x32_bf16 v[36:39], v[112:115], v[20:23], 0
    v_xor_b32 v179, 0x1a800, v178
    s_waitcnt vmcnt(8)
    buffer_load_dwordx4 v[152:155], v179, s[8:11], 0 offen nt
    v_mfma_f32_16x16x32_bf16 v[40:43], v[116:119], v[16:19], 0
    v_mfma_f32_16x16x32_bf16 v[44:47], v[116:119], v[20:23], 0
    s_nop 2
    v_add_f32 v8, v32, v38
    v_add_f32 v9, v33, v39
    v_xor_b32 v180, 0x12300, v178
    s_waitcnt vmcnt(8)
    buffer_load_dwordx4 v[156:159], v180, s[8:11], 0 offen nt
    v_mfma_f32_16x16x32_bf16 v[32:35], v[120:123], v[16:19], 0
    v_mfma_f32_16x16x32_bf16 v[36:39], v[120:123], v[20:23], 0
    v_add_f32_dpp v24, v9, v8 row_ror:8 row_mask:0xf bank_mask:0x3
    v_add_f32 v10, v40, v46
    v_add_f32 v11, v41, v47
    v_xor_b32 v179, 0x7a300, v178
    s_waitcnt vmcnt(8)
    buffer_load_dwordx4 v[160:163], v179, s[8:11], 0 offen nt
    v_mfma_f32_16x16x32_bf16 v[40:43], v[124:127], v[16:19], 0
    v_mfma_f32_16x16x32_bf16 v[44:47], v[124:127], v[20:23], 0
    v_add_f32_dpp v25, v11, v10 row_ror:8 row_mask:0xf bank_mask:0x3
    v_add_f32 v8, v32, v38
    v_add_f32 v9, v33, v39
    s_waitcnt vmcnt(8)
    v_mfma_f32_16x16x32_bf16 v[32:35], v[128:131], v[16:19], 0
    v_mfma_f32_16x16x32_bf16 v[36:39], v[128:131], v[20:23], 0
    v_add_f32_dpp v26, v9, v8 row_ror:8 row_mask:0xf bank_mask:0x3
    s_nop 0
    v_add_f32 v10, v40, v46
    v_add_f32 v11, v41, v47
    v_xor_b32 v180, 0x72800, v178
    s_waitcnt vmcnt(7)
    buffer_load_dwordx4 v[164:167], v180, s[8:11], 0 offen nt
    v_mfma_f32_16x16x32_bf16 v[40:43], v[132:135], v[16:19], 0
    v_mfma_f32_16x16x32_bf16 v[44:47], v[132:135], v[20:23], 0
    v_add_f32_dpp v27, v11, v10 row_ror:8 row_mask:0xf bank_mask:0x3
    v_add_f32 v8, v32, v38
    v_add_f32 v9, v33, v39
    v_xor_b32 v179, 0x68300, v178
    s_waitcnt vmcnt(7)
    buffer_load_dwordx4 v[168:171], v179, s[8:11], 0 offen nt
    v_mfma_f32_16x16x32_bf16 v[32:35], v[136:139], v[16:19], 0
    v_mfma_f32_16x16x32_bf16 v[36:39], v[136:139], v[20:23], 0
    v_add_f32_dpp v28, v9, v8 row_ror:8 row_mask:0xf bank_mask:0x3
    v_add_f32 v10, v40, v46
    v_add_f32 v11, v41, v47
    v_xor_b32 v180, 0x60800, v178
    s_waitcnt vmcnt(7)
    buffer_load_dwordx4 v[172:175], v180, s[8:11], 0 offen nt
    v_mfma_f32_16x16x32_bf16 v[40:43], v[140:143], v[16:19], 0
    v_mfma_f32_16x16x32_bf16 v[44:47], v[140:143], v[20:23], 0
    v_add_f32_dpp v29, v11, v10 row_ror:8 row_mask:0xf bank_mask:0x3
    v_add_f32 v8, v32, v38
    v_add_f32 v9, v33, v39
    s_cmp_eq_u32 s26, 1
    s_cselect_b32 s8, s12, s8
    s_cselect_b32 s9, s13, s9
    s_cselect_b64 vcc, -1, 0
    v_cndmask_b32 v1, v1, v2, vcc
    v_xor_b32 v178, s25, v1
    s_waitcnt vmcnt(7)
    buffer_load_dwordx4 v[112:115], v178, s[8:11], 0 offen nt
    v_mfma_f32_16x16x32_bf16 v[32:35], v[144:147], v[16:19], 0
    v_mfma_f32_16x16x32_bf16 v[36:39], v[144:147], v[20:23], 0
    v_add_f32_dpp v30, v9, v8 row_ror:8 row_mask:0xf bank_mask:0x3
    v_add_f32 v10, v40, v46
    v_add_f32 v11, v41, v47
    v_xor_b32 v180, 0x8b00, v178
    s_waitcnt vmcnt(7)
    buffer_load_dwordx4 v[116:119], v180, s[8:11], 0 offen nt
    v_mfma_f32_16x16x32_bf16 v[40:43], v[148:151], v[16:19], 0
    v_mfma_f32_16x16x32_bf16 v[44:47], v[148:151], v[20:23], 0
    v_add_f32_dpp v31, v11, v10 row_ror:8 row_mask:0xf bank_mask:0x3
    v_add_f32 v8, v32, v38
    v_add_f32 v9, v33, v39
    v_xor_b32 v179, 0x12000, v178
    s_waitcnt vmcnt(7)
    buffer_load_dwordx4 v[120:123], v179, s[8:11], 0 offen nt
    v_mfma_f32_16x16x32_bf16 v[32:35], v[152:155], v[16:19], 0
    v_mfma_f32_16x16x32_bf16 v[36:39], v[152:155], v[20:23], 0
    v_add_f32_dpp v24, v8, v9 row_ror:8 row_mask:0xf bank_mask:0xc
    v_add_f32 v10, v40, v46
    v_add_f32 v11, v41, v47
    v_xor_b32 v180, 0x1ab00, v178
    s_waitcnt vmcnt(7)
    buffer_load_dwordx4 v[124:127], v180, s[8:11], 0 offen nt
    v_mfma_f32_16x16x32_bf16 v[40:43], v[156:159], v[16:19], 0
    v_mfma_f32_16x16x32_bf16 v[44:47], v[156:159], v[20:23], 0
    v_add_f32_dpp v25, v10, v11 row_ror:8 row_mask:0xf bank_mask:0xc
    v_add_f32 v8, v32, v38
    v_add_f32 v9, v33, v39
    s_add_u32 s31, s33, 1
    s_mov_b32 s25, s24
    s_bitcmp1_b32 s31, 0
    s_cselect_b32 s3, 0x11300, 0
    s_xor_b32 s25, s25, s3
    s_bitcmp1_b32 s31, 1
    s_cselect_b32 s3, 0xc9200, 0
    s_xor_b32 s25, s25, s3
    s_bitcmp1_b32 s31, 2
    s_cselect_b32 s3, 0x4b000, 0
    s_xor_b32 s25, s25, s3
    s_bitcmp1_b32 s31, 3
    s_cselect_b32 s3, 0x94100, 0
    s_xor_b32 s25, s25, s3
    s_bitcmp1_b32 s31, 4
    s_cselect_b32 s3, 0x43f00, 0
    s_xor_b32 s25, s25, s3
    v_xor_b32 v179, 0x72b00, v178
    s_waitcnt vmcnt(7)
    buffer_load_dwordx4 v[128:131], v179, s[8:11], 0 offen nt
    v_mfma_f32_16x16x32_bf16 v[32:35], v[160:163], v[16:19], 0
    v_mfma_f32_16x16x32_bf16 v[36:39], v[160:163], v[20:23], 0
    v_add_f32_dpp v26, v8, v9 row_ror:8 row_mask:0xf bank_mask:0xc
    v_add_f32 v10, v40, v46
    v_add_f32 v11, v41, v47
    s_sub_u32 s26, s26, 1
    s_cmp_lt_u32 s33, s51
    s_cselect_b32 s60, s52, 10
    s_xor_b32 s60, s60, 8
    s_cmp_eq_u32 s26, 0
    s_cselect_b32 s60, 1, s60
    s_cmp_eq_u32 s33, s50
    s_cselect_b32 s60, 1, s60
    v_xor_b32 v180, 0x7a000, v178
    s_waitcnt vmcnt(7)
    buffer_load_dwordx4 v[132:135], v180, s[8:11], 0 offen nt
    v_mfma_f32_16x16x32_bf16 v[40:43], v[164:167], v[16:19], 0
    v_mfma_f32_16x16x32_bf16 v[44:47], v[164:167], v[20:23], 0
    v_add_f32_dpp v27, v10, v11 row_ror:8 row_mask:0xf bank_mask:0xc
    v_add_f32 v8, v32, v38
    v_add_f32 v9, v33, v39
    v_xor_b32 v179, 0x60b00, v178
    s_waitcnt vmcnt(7)
    buffer_load_dwordx4 v[136:139], v179, s[8:11], 0 offen nt
    v_mfma_f32_16x16x32_bf16 v[32:35], v[168:171], v[16:19], 0
    v_mfma_f32_16x16x32_bf16 v[36:39], v[168:171], v[20:23], 0
    v_add_f32_dpp v28, v8, v9 row_ror:8 row_mask:0xf bank_mask:0xc
    v_add_f32 v10, v40, v46
    v_add_f32 v11, v41, v47
    v_xor_b32 v180, 0x68000, v178
    s_waitcnt vmcnt(7)
    buffer_load_dwordx4 v[140:143], v180, s[8:11], 0 offen nt
    v_mfma_f32_16x16x32_bf16 v[40:43], v[172:175], v[16:19], 0
    v_mfma_f32_16x16x32_bf16 v[44:47], v[172:175], v[20:23], 0
    v_add_f32_dpp v29, v10, v11 row_ror:8 row_mask:0xf bank_mask:0xc
    v_add_f32 v8, v32, v38
    v_add_f32 v9, v33, v39
    s_nop 1
    v_add_f32_dpp v30, v8, v9 row_ror:8 row_mask:0xf bank_mask:0xc
    s_nop 1
    v_add_f32 v10, v40, v46
    v_add_f32 v11, v41, v47
    v_max3_f32 v5, v5, v24, v25
    v_max3_f32 v5, v5, v26, v27
    v_add_f32_dpp v31, v10, v11 row_ror:8 row_mask:0xf bank_mask:0xc
    ds_write_b128 v7, v[24:27]
    v_max3_f32 v5, v5, v28, v29
    v_max3_f32 v5, v5, v30, v31
    ds_write_b128 v7, v[28:31] offset:1024
    v_add_u32 v7, 2048, v7
    s_cmp_eq_u32 s60, 0
    s_cbranch_scc1 L_K8
    s_cmp_eq_u32 s26, 0
    s_cmp_lg_u32 s33, s50
    s_cbranch_scc1 L_K8_c
    s_call_b64 s[58:59], L_ctl
L_K8_c:
    s_cmp_eq_u32 s26, 0
    s_cbranch_scc1 L_T8
    s_cmp_lt_u32 s33, s51
    s_cselect_b32 s32, s52, 10
    s_cmp_gt_u32 s32, 8
    s_cbranch_scc1 L_K8_up
    s_branch L_K8
L_K8_up:
    v_xor_b32 v179, 0x8800, v178
    buffer_load_dwordx4 v[144:147], v179, s[8:11], 0 offen nt
    s_branch L_K9
.p2align 3
L_K9:
    v_xor_b32 v180, 0x300, v178
    s_waitcnt vmcnt(8)
    buffer_load_dwordx4 v[148:151], v180, s[8:11], 0 offen nt
L_K9_a:
    v_xor_b32 v179, 0x1a800, v178
    buffer_load_dwordx4 v[152:155], v179, s[8:11], 0 offen nt
    s_add_u32 s33, s33, 1
    v_mfma_f32_16x16x32_bf16 v[32:35], v[112:115], v[16:19], 0
    v_mfma_f32_16x16x32_bf16 v[36:39], v[112:115], v[20:23], 0
    v_xor_b32 v180, 0x12300, v178
    s_waitcnt vmcnt(9)
    buffer_load_dwordx4 v[156:159], v180, s[8:11], 0 offen nt
    v_mfma_f32_16x16x32_bf16 v[40:43], v[116:119], v[16:19], 0
    v_mfma_f32_16x16x32_bf16 v[44:47], v[116:119], v[20:23], 0
    s_nop 2
    v_add_f32 v8, v32, v38
    v_add_f32 v9, v33, v39
    v_xor_b32 v179, 0x7a300, v178
    s_waitcnt vmcnt(9)
    buffer_load_dwordx4 v[160:163], v179, s[8:11], 0 offen nt
    v_mfma_f32_16x16x32_bf16 v[32:35], v[120:123], v[16:19], 0
    v_mfma_f32_16x16x32_bf16 v[36:39], v[120:123], v[20:23], 0
    v_add_f32_dpp v24, v9, v8 row_ror:8 row_mask:0xf bank_mask:0x3
    v_add_f32 v10, v40, v46
    v_add_f32 v11, v41, v47
    v_xor_b32 v180, 0x72800, v178
    s_waitcnt vmcnt(9)
    buffer_load_dwordx4 v[164:167], v180, s[8:11], 0 offen nt
    v_mfma_f32_16x16x32_bf16 v[40:43], v[124:127], v[16:19], 0
    v_mfma_f32_16x16x32_bf16 v[44:47], v[124:127], v[20:23], 0
    v_add_f32_dpp v25, v11, v10 row_ror:8 row_mask:0xf bank_mask:0x3
    v_add_f32 v8, v32, v38
    v_add_f32 v9, v33, v39
    s_waitcnt vmcnt(9)
    v_mfma_f32_16x16x32_bf16 v[32:35], v[128:131], v[16:19], 0
    v_mfma_f32_16x16x32_bf16 v[36:39], v[128:131], v[20:23], 0
    v_add_f32_dpp v26, v9, v8 row_ror:8 row_mask:0xf bank_mask:0x3
    s_nop 0
    v_add_f32 v10, v40, v46
    v_add_f32 v11, v41, v47
    v_xor_b32 v179, 0x68300, v178
    s_waitcnt vmcnt(8)
    buffer_load_dwordx4 v[168:171], v179, s[8:11], 0 offen nt
    v_mfma_f32_16x16x32_bf16 v[40:43], v[132:135], v[16:19], 0
    v_mfma_f32_16x16x32_bf16 v[44:47], v[132:135], v[20:23], 0
    v_add_f32_dpp v27, v11, v10 row_ror:8 row_mask:0xf bank_mask:0x3
    v_add_f32 v8, v32, v38
    v_add_f32 v9, v33, v39
    v_xor_b32 v180, 0x60800, v178
    s_waitcnt vmcnt(8)
    buffer_load_dwordx4 v[172:175], v180, s[8:11], 0 offen nt
    v_mfma_f32_16x16x32_bf16 v[32:35], v[136:139], v[16:19], 0
    v_mfma_f32_16x16x32_bf16 v[36:39], v[136:139], v[20:23], 0
    v_add_f32_dpp v28, v9, v8 row_ror:8 row_mask:0xf bank_mask:0x3
    v_add_f32 v10, v40, v46
    v_add_f32 v11, v41, v47
    s_cmp_eq_u32 s26, 1
    s_cselect_b32 s8, s12, s8
    s_cselect_b32 s9, s13, s9
    s_cselect_b64 vcc, -1, 0
    v_cndmask_b32 v1, v1, v2, vcc
    v_xor_b32 v178, s25, v1
    s_waitcnt vmcnt(8)
    buffer_load_dwordx4 v[112:115], v178, s[8:11], 0 offen nt
    v_mfma_f32_16x16x32_bf16 v[40:43], v[140:143], v[16:19], 0
    v_mfma_f32_16x16x32_bf16 v[44:47], v[140:143], v[20:23], 0
    v_add_f32_dpp v29, v11, v10 row_ror:8 row_mask:0xf bank_mask:0x3
    v_add_f32 v8, v32, v38
    v_add_f32 v9, v33, v39
    v_xor_b32 v180, 0x8b00, v178
    s_waitcnt vmcnt(8)
    buffer_load_dwordx4 v[116:119], v180, s[8:11], 0 offen nt
    v_mfma_f32_16x16x32_bf16 v[32:35], v[144:147], v[16:19], 0
    v_mfma_f32_16x16x32_bf16 v[36:39], v[144:147], v[20:23], 0
    v_add_f32_dpp v30, v9, v8 row_ror:8 row_mask:0xf bank_mask:0x3
    v_add_f32 v10, v40, v46
    v_add_f32 v11, v41, v47
    v_xor_b32 v179, 0x12000, v178
    s_waitcnt vmcnt(8)
    buffer_load_dwordx4 v[120:123], v179, s[8:11], 0 offen nt
    v_mfma_f32_16x16x32_bf16 v[40:43], v[148:151], v[16:19], 0
    v_mfma_f32_16x16x32_bf16 v[44:47], v[148:151], v[20:23], 0
    v_add_f32_dpp v31, v11, v10 row_ror:8 row_mask:0xf bank_mask:0x3
    v_add_f32 v8, v32, v38
    v_add_f32 v9, v33, v39
    v_xor_b32 v180, 0x1ab00, v178
    s_waitcnt vmcnt(8)
    buffer_load_dwordx4 v[124:127], v180, s[8:11], 0 offen nt
    v_mfma_f32_16x16x32_bf16 v[32:35], v[152:155], v[16:19], 0
    v_mfma_f32_16x16x32_bf16 v[36:39], v[152:155], v[20:23], 0
    v_add_f32_dpp v24, v8, v9 row_ror:8 row_mask:0xf bank_mask:0xc
    v_add_f32 v10, v40, v46
    v_add_f32 v11, v41, v47
    v_xor_b32 v179, 0x72b00, v178
    s_waitcnt vmcnt(8)
    buffer_load_dwordx4 v[128:131], v179, s[8:11], 0 offen nt
    v_mfma_f32_16x16x32_bf16 v[40:43], v[156:159], v[16:19], 0
    v_mfma_f32_16x16x32_bf16 v[44:47], v[156:159], v[20:23], 0
    v_add_f32_dpp v25, v10, v11 row_ror:8 row_mask:0xf bank_mask:0xc
    v_add_f32 v8, v32, v38
    v_add_f32 v9, v33, v39
    s_add_u32 s31, s33, 1
    s_mov_b32 s25, s24
    s_bitcmp1_b32 s31, 0
    s_cselect_b32 s3, 0x11300, 0
    s_xor_b32 s25, s25, s3
    s_bitcmp1_b32 s31, 1
    s_cselect_b32 s3, 0xc9200, 0
    s_xor_b32 s25, s25, s3
    s_bitcmp1_b32 s31, 2
    s_cselect_b32 s3, 0x4b000, 0
    s_xor_b32 s25, s25, s3
    s_bitcmp1_b32 s31, 3
    s_cselect_b32 s3, 0x94100, 0
    s_xor_b32 s25, s25, s3
    s_bitcmp1_b32 s31, 4
    s_cselect_b32 s3, 0x43f00, 0
    s_xor_b32 s25, s25, s3
    v_xor_b32 v180, 0x7a000, v178
    s_waitcnt vmcnt(8)
    buffer_load_dwordx4 v[132:135], v180, s[8:11], 0 offen nt
    v_mfma_f32_16x16x32_bf16 v[32:35], v[160:163], v[16:19], 0
    v_mfma_f32_16x16x32_bf16 v[36:39], v[160:163], v[20:23], 0
    v_add_f32_dpp v26, v8, v9 row_ror:8 row_mask:0xf bank_mask:0xc
    v_add_f32 v10, v40, v46
    v_add_f32 v11, v41, v47
    s_sub_u32 s26, s26, 1
    s_cmp_lt_u32 s33, s51
    s_cselect_b32 s60, s52, 10
    s_xor_b32 s60, s60, 9
    s_cmp_eq_u32 s26, 0
    s_cselect_b32 s60, 1, s60
    s_cmp_eq_u32 s33, s50
    s_cselect_b32 s60, 1, s60
    v_xor_b32 v179, 0x60b00, v178
    s_waitcnt vmcnt(8)
    buffer_load_dwordx4 v[136:139], v179, s[8:11], 0 offen nt
    v_mfma_f32_16x16x32_bf16 v[40:43], v[164:167], v[16:19], 0
    v_mfma_f32_16x16x32_bf16 v[44:47], v[164:167], v[20:23], 0
    v_add_f32_dpp v27, v10, v11 row_ror:8 row_mask:0xf bank_mask:0xc
    v_add_f32 v8, v32, v38
    v_add_f32 v9, v33, v39
    v_xor_b32 v180, 0x68000, v178
    s_waitcnt vmcnt(8)
    buffer_load_dwordx4 v[140:143], v180, s[8:11], 0 offen nt
    v_mfma_f32_16x16x32_bf16 v[32:35], v[168:171], v[16:19], 0
    v_mfma_f32_16x16x32_bf16 v[36:39], v[168:171], v[20:23], 0
    v_add_f32_dpp v28, v8, v9 row_ror:8 row_mask:0xf bank_mask:0xc
    v_add_f32 v10, v40, v46
    v_add_f32 v11, v41, v47
    v_xor_b32 v179, 0x8800, v178
    s_waitcnt vmcnt(8)
    buffer_load_dwordx4 v[144:147], v179, s[8:11], 0 offen nt
    v_mfma_f32_16x16x32_bf16 v[40:43], v[172:175], v[16:19], 0
    v_mfma_f32_16x16x32_bf16 v[44:47], v[172:175], v[20:23], 0
    v_add_f32_dpp v29, v10, v11 row_ror:8 row_mask:0xf bank_mask:0xc
    v_add_f32 v8, v32, v38
    v_add_f32 v9, v33, v39
    s_nop 1
    v_add_f32_dpp v30, v8, v9 row_ror:8 row_mask:0xf bank_mask:0xc
    s_nop 1
    v_add_f32 v10, v40, v46
    v_add_f32 v11, v41, v47
    v_max3_f32 v5, v5, v24, v25
    v_max3_f32 v5, v5, v26, v27
    v_add_f32_dpp v31, v10, v11 row_ror:8 row_mask:0xf bank_mask:0xc
    ds_write_b128 v7, v[24:27]
    v_max3_f32 v5, v5, v28, v29
    v_max3_f32 v5, v5, v30, v31
    ds_write_b128 v7, v[28:31] offset:1024
    v_add_u32 v7, 2048, v7
    s_cmp_eq_u32 s60, 0
    s_cbranch_scc1 L_K9
    s_cmp_eq_u32 s26, 0
    s_cmp_lg_u32 s33, s50
    s_cbranch_scc1 L_K9_c
    s_call_b64 s[58:59], L_ctl
L_K9_c:
    s_cmp_eq_u32 s26, 0
    s_cbranch_scc1 L_T9
    s_cmp_lt_u32 s33, s51
    s_cselect_b32 s32, s52, 10
    s_cmp_gt_u32 s32, 9
    s_cbranch_scc1 L_K9_up
    s_cmp_ge_u32 s32, 9
    s_cbranch_scc1 L_K9
    s_waitcnt vmcnt(8)
    s_branch L_K8_a
L_K9_up:
    v_xor_b32 v180, 0x300, v178
    buffer_load_dwordx4 v[148:151], v180, s[8:11], 0 offen nt
    s_branch L_K10
.p2align 3
L_K11:
    v_xor_b32 v180, 0x12300, v178
    s_waitcnt vmcnt(10)
    buffer_load_dwordx4 v[156:159], v180, s[8:11], 0 offen nt
L_K11_a:
    v_xor_b32 v179, 0x7a300, v178
    buffer_load_dwordx4 v[160:163], v179, s[8:11], 0 offen nt
    s_add_u32 s33, s33, 1
    v_mfma_f32_16x16x32_bf16 v[32:35], v[112:115], v[16:19], 0
    v_mfma_f32_16x16x32_bf16 v[36:39], v[112:115], v[20:23], 0
    v_xor_b32 v180, 0x72800, v178
    s_waitcnt vmcnt(11)
    buffer_load_dwordx4 v[164:167], v180, s[8:11], 0 offen nt
    v_mfma_f32_16x16x32_bf16 v[40:43], v[116:119], v[16:19], 0
    v_mfma_f32_16x16x32_bf16 v[44:47], v[116:119], v[20:23], 0
    s_nop 2
    v_add_f32 v8, v32, v38
    v_add_f32 v9, v33, v39
    v_xor_b32 v179, 0x68300, v178
    s_waitcnt vmcnt(11)
    buffer_load_dwordx4 v[168:171], v179, s[8:11], 0 offen nt
    v_mfma_f32_16x16x32_bf16 v[32:35], v[120:123], v[16:19], 0
    v_mfma_f32_16x16x32_bf16 v[36:39], v[120:123], v[20:23], 0
    v_add_f32_dpp v24, v9, v8 row_ror:8 row_mask:0xf bank_mask:0x3
    v_add_f32 v10, v40, v46
    v_add_f32 v11, v41, v47
    v_xor_b32 v180, 0x60800, v178
    s_waitcnt vmcnt(11)
    buffer_load_dwordx4 v[172:175], v180, s[8:11], 0 offen nt
    v_mfma_f32_16x16x32_bf16 v[40:43], v[124:127], v[16:19], 0
    v_mfma_f32_16x16x32_bf16 v[44:47], v[124:127], v[20:23], 0
    v_add_f32_dpp v25, v11, v10 row_ror:8 row_mask:0xf bank_mask:0x3
    v_add_f32 v8, v32, v38
    v_add_f32 v9, v33, v39
    s_waitcnt vmcnt(11)
    v_mfma_f32_16x16x32_bf16 v[32:35], v[128:131], v[16:19], 0
    v_mfma_f32_16x16x32_bf16 v[36:39], v[128:131], v[20:23], 0
    v_add_f32_dpp v26, v9, v8 row_ror:8 row_mask:0xf bank_mask:0x3
    s_nop 0
    v_add_f32 v10, v40, v46
    v_add_f32 v11, v41, v47
    s_cmp_eq_u32 s26, 1
    s_cselect_b32 s8, s12, s8
    s_cselect_b32 s9, s13, s9
    s_cselect_b64 vcc, -1, 0
    v_cndmask_b32 v1, v1, v2, vcc
    v_xor_b32 v178, s25, v1
    s_waitcnt vmcnt(10)
    buffer_load_dwordx4 v[112:115], v178, s[8:11], 0 offen nt
    v_mfma_f32_16x16x32_bf16 v[40:43], v[132:135], v[16:19], 0
    v_mfma_f32_16x16x32_bf16 v[44:47], v[132:135], v[20:23], 0
    v_add_f32_dpp v27, v11, v10 row_ror:8 row_mask:0xf bank_mask:0x3
    v_add_f32 v8, v32, v38
    v_add_f32 v9, v33, v39
    v_xor_b32 v180, 0x8b00, v178
    s_waitcnt vmcnt(10)
    buffer_load_dwordx4 v[116:119], v180, s[8:11], 0 offen nt
    v_mfma_f32_16x16x32_bf16 v[32:35], v[136:139], v[16:19], 0
    v_mfma_f32_16x16x32_bf16 v[36:39], v[136:139], v[20:23], 0
    v_add_f32_dpp v28, v9, v8 row_ror:8 row_mask:0xf bank_mask:0x3
    v_add_f32 v10, v40, v46
    v_add_f32 v11, v41, v47
    v_xor_b32 v179, 0x12000, v178
    s_waitcnt vmcnt(10)
    buffer_load_dwordx4 v[120:123], v179, s[8:11], 0 offen nt
    v_mfma_f32_16x16x32_bf16 v[40:43], v[140:143], v[16:19], 0
    v_mfma_f32_16x16x32_bf16 v[44:47], v[140:143], v[20:23], 0
    v_add_f32_dpp v29, v11, v10 row_ror:8 row_mask:0xf bank_mask:0x3
    v_add_f32 v8, v32, v38
    v_add_f32 v9, v33, v39
    v_xor_b32 v180, 0x1ab00, v178
    s_waitcnt vmcnt(10)
    buffer_load_dwordx4 v[124:127], v180, s[8:11], 0 offen nt
    v_mfma_f32_16x16x32_bf16 v[32:35], v[144:147], v[16:19], 0
    v_mfma_f32_16x16x32_bf16 v[36:39], v[144:147], v[20:23], 0
    v_add_f32_dpp v30, v9, v8 row_ror:8 row_mask:0xf bank_mask:0x3
    v_add_f32 v10, v40, v46
    v_add_f32 v11, v41, v47
    v_xor_b32 v179, 0x72b00, v178
    s_waitcnt vmcnt(10)
    buffer_load_dwordx4 v[128:131], v179, s[8:11], 0 offen nt
    v_mfma_f32_16x16x32_bf16 v[40:43], v[148:151], v[16:19], 0
    v_mfma_f32_16x16x32_bf16 v[44:47], v[148:151], v[20:23], 0
    v_add_f32_dpp v31, v11, v10 row_ror:8 row_mask:0xf bank_mask:0x3
    v_add_f32 v8, v32, v38
    v_add_f32 v9, v33, v39
    v_xor_b32 v180, 0x7a000, v178
    s_waitcnt vmcnt(10)
    buffer_load_dwordx4 v[132:135], v180, s[8:11], 0 offen nt
    v_mfma_f32_16x16x32_bf16 v[32:35], v[152:155], v[16:19], 0
    v_mfma_f32_16x16x32_bf16 v[36:39], v[152:155], v[20:23], 0
    v_add_f32_dpp v24, v8, v9 row_ror:8 row_mask:0xf bank_mask:0xc
    v_add_f32 v10, v40, v46
    v_add_f32 v11, v41, v47
    v_xor_b32 v179, 0x60b00, v178
    s_waitcnt vmcnt(10)
    buffer_load_dwordx4 v[136:139], v179, s[8:11], 0 offen nt
    v_mfma_f32_16x16x32_bf16 v[40:43], v[156:159], v[16:19], 0
    v_mfma_f32_16x16x32_bf16 v[44:47], v[156:159], v[20:23], 0
    v_add_f32_dpp v25, v10, v11 row_ror:8 row_mask:0xf bank_mask:0xc
    v_add_f32 v8, v32, v38
    v_add_f32 v9, v33, v39
    s_add_u32 s31, s33, 1
    s_mov_b32 s25, s24
    s_bitcmp1_b32 s31, 0
    s_cselect_b32 s3, 0x11300, 0
    s_xor_b32 s25, s25, s3
    s_bitcmp1_b32 s31, 1
    s_cselect_b32 s3, 0xc9200, 0
    s_xor_b32 s25, s25, s3
    s_bitcmp1_b32 s31, 2
    s_cselect_b32 s3, 0x4b000, 0
    s_xor_b32 s25, s25, s3
    s_bitcmp1_b32 s31, 3
    s_cselect_b32 s3, 0x94100, 0
    s_xor_b32 s25, s25, s3
    s_bitcmp1_b32 s31, 4
    s_cselect_b32 s3, 0x43f00, 0
    s_xor_b32 s25, s25, s3
    v_xor_b32 v180, 0x68000, v178
    s_waitcnt vmcnt(10)
    buffer_load_dwordx4 v[140:143], v180, s[8:11], 0 offen nt
    v_mfma_f32_16x16x32_bf16 v[32:35], v[160:163], v[16:19], 0
    v_mfma_f32_16x16x32_bf16 v[36:39], v[160:163], v[20:23], 0
    v_add_f32_dpp v26, v8, v9 row_ror:8 row_mask:0xf bank_mask:0xc
    v_add_f32 v10, v40, v46
    v_add_f32 v11, v41, v47
    s_sub_u32 s26, s26, 1
    s_cmp_lt_u32 s33, s51
    s_cselect_b32 s60, s52, 10
    s_xor_b32 s60, s60, 11
    s_cmp_eq_u32 s26, 0
    s_cselect_b32 s60, 1, s60
    s_cmp_eq_u32 s33, s50
    s_cselect_b32 s60, 1, s60
    v_xor_b32 v179, 0x8800, v178
    s_waitcnt vmcnt(10)
    buffer_load_dwordx4 v[144:147], v179, s[8:11], 0 offen nt
    v_mfma_f32_16x16x32_bf16 v[40:43], v[164:167], v[16:19], 0
    v_mfma_f32_16x16x32_bf16 v[44:47], v[164:167], v[20:23], 0
    v_add_f32_dpp v27, v10, v11 row_ror:8 row_mask:0xf bank_mask:0xc
    v_add_f32 v8, v32, v38
    v_add_f32 v9, v33, v39
    v_xor_b32 v180, 0x300, v178
    s_waitcnt vmcnt(10)
    buffer_load_dwordx4 v[148:151], v180, s[8:11], 0 offen nt
    v_mfma_f32_16x16x32_bf16 v[32:35], v[168:171], v[16:19], 0
    v_mfma_f32_16x16x32_bf16 v[36:39], v[168:171], v[20:23], 0
    v_add_f32_dpp v28, v8, v9 row_ror:8 row_mask:0xf bank_mask:0xc
    v_add_f32 v10, v40, v46
    v_add_f32 v11, v41, v47
    v_xor_b32 v179, 0x1a800, v178
    s_waitcnt vmcnt(10)
    buffer_load_dwordx4 v[152:155], v179, s[8:11], 0 offen nt
    v_mfma_f32_16x16x32_bf16 v[40:43], v[172:175], v[16:19], 0
    v_mfma_f32_16x16x32_bf16 v[44:47], v[172:175], v[20:23], 0
    v_add_f32_dpp v29, v10, v11 row_ror:8 row_mask:0xf bank_mask:0xc
    v_add_f32 v8, v32, v38
    v_add_f32 v9, v33, v39
    s_nop 1
    v_add_f32_dpp v30, v8, v9 row_ror:8 row_mask:0xf bank_mask:0xc
    s_nop 1
    v_add_f32 v10, v40, v46
    v_add_f32 v11, v41, v47
    v_max3_f32 v5, v5, v24, v25
    v_max3_f32 v5, v5, v26, v27
    v_add_f32_dpp v31, v10, v11 row_ror:8 row_mask:0xf bank_mask:0xc
    ds_write_b128 v7, v[24:27]
    v_max3_f32 v5, v5, v28, v29
    v_max3_f32 v5, v5, v30, v31
    ds_write_b128 v7, v[28:31] offset:1024
    v_add_u32 v7, 2048, v7
    s_cmp_eq_u32 s60, 0
    s_cbranch_scc1 L_K11
    s_cmp_eq_u32 s26, 0
    s_cmp_lg_u32 s33, s50
    s_cbranch_scc1 L_K11_c
    s_call_b64 s[58:59], L_ctl
L_K11_c:
    s_cmp_eq_u32 s26, 0
    s_cbranch_scc1 L_T11
    s_cmp_lt_u32 s33, s51
    s_cselect_b32 s32, s52, 10
    s_cmp_gt_u32 s32, 11
    s_cbranch_scc1 L_K11_up
    s_cmp_ge_u32 s32, 11
    s_cbranch_scc1 L_K11
    s_waitcnt vmcnt(10)
    s_branch L_K10_a
L_K11_up:
    v_xor_b32 v180, 0x12300, v178
    buffer_load_dwordx4 v[156:159], v180, s[8:11], 0 offen nt
    s_branch L_K12
.p2align 3
L_K12:
    v_xor_b32 v179, 0x7a300, v178
    s_waitcnt vmcnt(11)
    buffer_load_dwordx4 v[160:163], v179, s[8:11], 0 offen nt
L_K12_a:
    v_xor_b32 v180, 0x72800, v178
    buffer_load_dwordx4 v[164:167], v180, s[8:11], 0 offen nt
    s_add_u32 s33, s33, 1
    v_mfma_f32_16x16x32_bf16 v[32:35], v[112:115], v[16:19], 0
    v_mfma_f32_16x16x32_bf16 v[36:39], v[112:115], v[20:23], 0
    v_xor_b32 v179, 0x68300, v178
    s_waitcnt vmcnt(12)
    buffer_load_dwordx4 v[168:171], v179, s[8:11], 0 offen nt
    v_mfma_f32_16x16x32_bf16 v[40:43], v[116:119], v[16:19], 0
    v_mfma_f32_16x16x32_bf16 v[44:47], v[116:119], v[20:23], 0
    s_nop 2
    v_add_f32 v8, v32, v38
    v_add_f32 v9, v33, v39
    v_xor_b32 v180, 0x60800, v178
    s_waitcnt vmcnt(12)
    buffer_load_dwordx4 v[172:175], v180, s[8:11], 0 offen nt
    v_mfma_f32_16x16x32_bf16 v[32:35], v[120:123], v[16:19], 0
    v_mfma_f32_16x16x32_bf16 v[36:39], v[120:123], v[20:23], 0
    v_add_f32_dpp v24, v9, v8 row_ror:8 row_mask:0xf bank_mask:0x3
    v_add_f32 v10, v40, v46
    v_add_f32 v11, v41, v47
    s_cmp_eq_u32 s26, 1
    s_cselect_b32 s8, s12, s8
    s_cselect_b32 s9, s13, s9
    s_cselect_b64 vcc, -1, 0
    v_cndmask_b32 v1, v1, v2, vcc
    v_xor_b32 v178, s25, v1
    s_waitcnt vmcnt(12)
    buffer_load_dwordx4 v[112:115], v178, s[8:11], 0 offen nt
    v_mfma_f32_16x16x32_bf16 v[40:43], v[124:127], v[16:19], 0
    v_mfma_f32_16x16x32_bf16 v[44:47], v[124:127], v[20:23], 0
    v_add_f32_dpp v25, v11, v10 row_ror:8 row_mask:0xf bank_mask:0x3
    v_add_f32 v8, v32, v38
    v_add_f32 v9, v33, v39
    s_waitcnt vmcnt(12)
    v_mfma_f32_16x16x32_bf16 v[32:35], v[128:131], v[16:19], 0
    v_mfma_f32_16x16x32_bf16 v[36:39], v[128:131], v[20:23], 0
    v_add_f32_dpp v26, v9, v8 row_ror:8 row_mask:0xf bank_mask:0x3
    s_nop 0
    v_add_f32 v10, v40, v46
    v_add_f32 v11, v41, v47
    v_xor_b32 v180, 0x8b00, v178
    s_waitcnt vmcnt(11)
    buffer_load_dwordx4 v[116:119], v180, s[8:11], 0 offen nt
    v_mfma_f32_16x16x32_bf16 v[40:43], v[132:135], v[16:19], 0
    v_mfma_f32_16x16x32_bf16 v[44:47], v[132:135], v[20:23], 0
    v_add_f32_dpp v27, v11, v10 row_ror:8 row_mask:0xf bank_mask:0x3
    v_add_f32 v8, v32, v38
    v_add_f32 v9, v33, v39
    v_xor_b32 v179, 0x12000, v178
    s_waitcnt vmcnt(11)
    buffer_load_dwordx4 v[120:123], v179, s[8:11], 0 offen nt
    v_mfma_f32_16x16x32_bf16 v[32:35], v[136:139], v[16:19], 0
    v_mfma_f32_16x16x32_bf16 v[36:39], v[136:139], v[20:23], 0
    v_add_f32_dpp v28, v9, v8 row_ror:8 row_mask:0xf bank_mask:0x3
    v_add_f32 v10, v40, v46
    v_add_f32 v11, v41, v47
    v_xor_b32 v180, 0x1ab00, v178
    s_waitcnt vmcnt(11)
    buffer_load_dwordx4 v[124:127], v180, s[8:11], 0 offen nt
    v_mfma_f32_16x16x32_bf16 v[40:43], v[140:143], v[16:19], 0
    v_mfma_f32_16x16x32_bf16 v[44:47], v[140:143], v[20:23], 0
    v_add_f32_dpp v29, v11, v10 row_ror:8 row_mask:0xf bank_mask:0x3
    v_add_f32 v8, v32, v38
    v_add_f32 v9, v33, v39
    v_xor_b32 v179, 0x72b00, v178
    s_waitcnt vmcnt(11)
    buffer_load_dwordx4 v[128:131], v179, s[8:11], 0 offen nt
    v_mfma_f32_16x16x32_bf16 v[32:35], v[144:147], v[16:19], 0
    v_mfma_f32_16x16x32_bf16 v[36:39], v[144:147], v[20:23], 0
    v_add_f32_dpp v30, v9, v8 row_ror:8 row_mask:0xf bank_mask:0x3
    v_add_f32 v10, v40, v46
    v_add_f32 v11, v41, v47
    v_xor_b32 v180, 0x7a000, v178
    s_waitcnt vmcnt(11)
    buffer_load_dwordx4 v[132:135], v180, s[8:11], 0 offen nt
    v_mfma_f32_16x16x32_bf16 v[40:43], v[148:151], v[16:19], 0
    v_mfma_f32_16x16x32_bf16 v[44:47], v[148:151], v[20:23], 0
    v_add_f32_dpp v31, v11, v10 row_ror:8 row_mask:0xf bank_mask:0x3
    v_add_f32 v8, v32, v38
    v_add_f32 v9, v33, v39
    v_xor_b32 v179, 0x60b00, v178
    s_waitcnt vmcnt(11)
    buffer_load_dwordx4 v[136:139], v179, s[8:11], 0 offen nt
    v_mfma_f32_16x16x32_bf16 v[32:35], v[152:155], v[16:19], 0
    v_mfma_f32_16x16x32_bf16 v[36:39], v[152:155], v[20:23], 0
    v_add_f32_dpp v24, v8, v9 row_ror:8 row_mask:0xf bank_mask:0xc
    v_add_f32 v10, v40, v46
    v_add_f32 v11, v41, v47
    v_xor_b32 v180, 0x68000, v178
    s_waitcnt vmcnt(11)
    buffer_load_dwordx4 v[140:143], v180, s[8:11], 0 offen nt
    v_mfma_f32_16x16x32_bf16 v[40:43], v[156:159], v[16:19], 0
    v_mfma_f32_16x16x32_bf16 v[44:47], v[156:159], v[20:23], 0
    v_add_f32_dpp v25, v10, v11 row_ror:8 row_mask:0xf bank_mask:0xc
    v_add_f32 v8, v32, v38
    v_add_f32 v9, v33, v39
    s_add_u32 s31, s33, 1
    s_mov_b32 s25, s24
    s_bitcmp1_b32 s31, 0
    s_cselect_b32 s3, 0x11300, 0
    s_xor_b32 s25, s25, s3
    s_bitcmp1_b32 s31, 1
    s_cselect_b32 s3, 0xc9200, 0
    s_xor_b32 s25, s25, s3
    s_bitcmp1_b32 s31, 2
    s_cselect_b32 s3, 0x4b000, 0
    s_xor_b32 s25, s25, s3
    s_bitcmp1_b32 s31, 3
    s_cselect_b32 s3, 0x94100, 0
    s_xor_b32 s25, s25, s3
    s_bitcmp1_b32 s31, 4
    s_cselect_b32 s3, 0x43f00, 0
    s_xor_b32 s25, s25, s3
    v_xor_b32 v179, 0x8800, v178
    s_waitcnt vmcnt(11)
    buffer_load_dwordx4 v[144:147], v179, s[8:11], 0 offen nt
    v_mfma_f32_16x16x32_bf16 v[32:35], v[160:163], v[16:19], 0
    v_mfma_f32_16x16x32_bf16 v[36:39], v[160:163], v[20:23], 0
    v_add_f32_dpp v26, v8, v9 row_ror:8 row_mask:0xf bank_mask:0xc
    v_add_f32 v10, v40, v46
    v_add_f32 v11, v41, v47
    s_sub_u32 s26, s26, 1
    s_cmp_lt_u32 s33, s51
    s_cselect_b32 s60, s52, 10
    s_xor_b32 s60, s60, 12
    s_cmp_eq_u32 s26, 0
    s_cselect_b32 s60, 1, s60
    s_cmp_eq_u32 s33, s50
    s_cselect_b32 s60, 1, s60
    v_xor_b32 v180, 0x300, v178
    s_waitcnt vmcnt(11)
    buffer_load_dwordx4 v[148:151], v180, s[8:11], 0 offen nt
    v_mfma_f32_16x16x32_bf16 v[40:43], v[164:167], v[16:19], 0
    v_mfma_f32_16x16x32_bf16 v[44:47], v[164:167], v[20:23], 0
    v_add_f32_dpp v27, v10, v11 row_ror:8 row_mask:0xf bank_mask:0xc
    v_add_f32 v8, v32, v38
    v_add_f32 v9, v33, v39
    v_xor_b32 v179, 0x1a800, v178
    s_waitcnt vmcnt(11)
    buffer_load_dwordx4 v[152:155], v179, s[8:11], 0 offen nt
    v_mfma_f32_16x16x32_bf16 v[32:35], v[168:171], v[16:19], 0
    v_mfma_f32_16x16x32_bf16 v[36:39], v[168:171], v[20:23], 0
    v_add_f32_dpp v28, v8, v9 row_ror:8 row_mask:0xf bank_mask:0xc
    v_add_f32 v10, v40, v46
    v_add_f32 v11, v41, v47
    v_xor_b32 v180, 0x12300, v178
    s_waitcnt vmcnt(11)
    buffer_load_dwordx4 v[156:159], v180, s[8:11], 0 offen nt
    v_mfma_f32_16x16x32_bf16 v[40:43], v[172:175], v[16:19], 0
    v_mfma_f32_16x16x32_bf16 v[44:47], v[172:175], v[20:23], 0
    v_add_f32_dpp v29, v10, v11 row_ror:8 row_mask:0xf bank_mask:0xc
    v_add_f32 v8, v32, v38
    v_add_f32 v9, v33, v39
    s_nop 1
    v_add_f32_dpp v30, v8, v9 row_ror:8 row_mask:0xf bank_mask:0xc
    s_nop 1
    v_add_f32 v10, v40, v46
    v_add_f32 v11, v41, v47
    v_max3_f32 v5, v5, v24, v25
    v_max3_f32 v5, v5, v26, v27
    v_add_f32_dpp v31, v10, v11 row_ror:8 row_mask:0xf bank_mask:0xc
    ds_write_b128 v7, v[24:27]
    v_max3_f32 v5, v5, v28, v29
    v_max3_f32 v5, v5, v30, v31
    ds_write_b128 v7, v[28:31] offset:1024
    v_add_u32 v7, 2048, v7
    s_cmp_eq_u32 s60, 0
    s_cbranch_scc1 L_K12
    s_cmp_eq_u32 s26, 0
    s_cmp_lg_u32 s33, s50
    s_cbranch_scc1 L_K12_c
    s_call_b64 s[58:59], L_ctl
L_K12_c:
    s_cmp_eq_u32 s26, 0
    s_cbranch_scc1 L_T12
    s_cmp_lt_u32 s33, s51
    s_cselect_b32 s32, s52, 10
    s_cmp_ge_u32 s32, 12
    s_cbranch_scc1 L_K12
    s_waitcnt vmcnt(11)
    s_branch L_K11_a
L_T12:
    v_subrev_u32 v7, 65536, v7
    ds_read_b128 v[24:27], v7
    ds_read_b128 v[28:31], v7 offset:1024
    ds_read_b32 v189, v7
    v_max_f32_dpp v5, v5, v5 row_ror:8 row_mask:0xf bank_mask:0xf
    s_mov_b32 s26, 32
    v_mov_b32 v4, v5
    s_nop 1
    v_permlane32_swap_b32 v5, v4
    v_max_f32 v5, v5, v4
    v_mov_b32 v4, v5
    s_nop 1
    v_permlane16_swap_b32 v5, v4
    v_max_f32 v5, v5, v4
    s_waitcnt lgkmcnt(1)
    v_sub_f32 v24, v24, v5
    v_sub_f32 v25, v25, v5
    v_sub_f32 v26, v26, v5
    v_sub_f32 v27, v27, v5
    v_sub_f32 v28, v28, v5
    v_sub_f32 v29, v29, v5
    v_sub_f32 v30, v30, v5
    v_sub_f32 v31, v31, v5
    v_mul_f32 v24, s28, v24
    v_mul_f32 v25, s28, v25
    v_mul_f32 v26, s28, v26
    v_mul_f32 v27, s28, v27
    v_mul_f32 v28, s28, v28
    v_mul_f32 v29, s28, v29
    v_mul_f32 v30, s28, v30
    v_mul_f32 v31, s28, v31
.p2align 3
L_V12:
    v_xor_b32 v179, 0x7a300, v178
    s_waitcnt vmcnt(11)
    buffer_load_dwordx4 v[160:163], v179, s[8:11], 0 offen nt
L_V12_a:
    v_xor_b32 v180, 0x72800, v178
    buffer_load_dwordx4 v[164:167], v180, s[8:11], 0 offen nt
    s_add_u32 s33, s33, 1
    v_exp_f32 v24, v24
    v_exp_f32 v25, v25
    v_exp_f32 v26, v26
    v_exp_f32 v27, v27
    v_exp_f32 v28, v28
    v_xor_b32 v179, 0x68300, v178
    s_waitcnt vmcnt(12)
    buffer_load_dwordx4 v[168:171], v179, s[8:11], 0 offen nt
    v_perm_b32 v48, v116, v112, s29
    v_perm_b32 v52, v116, v112, s30
    v_perm_b32 v56, v117, v113, s29
    v_perm_b32 v60, v117, v113, s30
    v_perm_b32 v64, v118, v114, s29
    v_perm_b32 v68, v118, v114, s30
    v_perm_b32 v72, v119, v115, s29
    v_perm_b32 v76, v119, v115, s30
    v_xor_b32 v180, 0x60800, v178
    s_waitcnt vmcnt(12)
    buffer_load_dwordx4 v[172:175], v180, s[8:11], 0 offen nt
    v_exp_f32 v29, v29
    v_exp_f32 v30, v30
    v_exp_f32 v31, v31
    v_add_f32 v3, v24, v25
    v_add_f32 v4, v26, v27
    s_cmp_eq_u32 s26, 1
    s_cselect_b32 s10, 0, s10
    v_xor_b32 v178, s25, v1
    s_waitcnt vmcnt(12)
    buffer_load_dwordx4 v[112:115], v178, s[8:11], 0 offen nt
    v_perm_b32 v49, v124, v120, s29
    v_perm_b32 v53, v124, v120, s30
    v_perm_b32 v57, v125, v121, s29
    v_perm_b32 v61, v125, v121, s30
    v_perm_b32 v65, v126, v122, s29
    v_perm_b32 v69, v126, v122, s30
    v_perm_b32 v73, v127, v123, s29
    v_perm_b32 v77, v127, v123, s30
    v_xor_b32 v180, 0x8b00, v178
    s_waitcnt vmcnt(12)
    buffer_load_dwordx4 v[116:119], v180, s[8:11], 0 offen nt
    v_cvt_pk_bf16_f32 v16, v24, v25
    v_cvt_pk_bf16_f32 v17, v26, v27
    v_cvt_pk_bf16_f32 v18, v28, v29
    v_cvt_pk_bf16_f32 v19, v30, v31
    v_cvt_pk_bf16_f32 v12, v24, v25
    v_cvt_pk_bf16_f32 v13, v26, v27
    v_cvt_pk_bf16_f32 v14, v28, v29
    v_cvt_pk_bf16_f32 v15, v30, v31
    v_add_f32 v3, v3, v28
    v_add_f32 v4, v4, v29
    v_add_f32 v3, v3, v30
    v_add_f32 v4, v4, v31
    v_add_f32 v6, v6, v3
    v_add_f32 v6, v6, v4
    v_xor_b32 v179, 0x12000, v178
    s_waitcnt vmcnt(12)
    buffer_load_dwordx4 v[120:123], v179, s[8:11], 0 offen nt
    v_perm_b32 v50, v132, v128, s29
    v_perm_b32 v54, v132, v128, s30
    v_perm_b32 v58, v133, v129, s29
    v_perm_b32 v62, v133, v129, s30
    v_perm_b32 v66, v134, v130, s29
    v_perm_b32 v70, v134, v130, s30
    v_perm_b32 v74, v135, v131, s29
    v_perm_b32 v78, v135, v131, s30
    s_waitcnt vmcnt(12)
    v_add_u32 v7, 2048, v7
    ds_read_b128 v[24:27], v7
    ds_read_b128 v[28:31], v7 offset:1024
    ds_read_b32 v189, v7
    v_mov_b32_dpp v16, v16 row_ror:8 row_mask:0xf bank_mask:0xc
    v_mov_b32_dpp v17, v17 row_ror:8 row_mask:0xf bank_mask:0xc
    v_mov_b32_dpp v18, v18 row_ror:8 row_mask:0xf bank_mask:0xc
    v_mov_b32_dpp v19, v19 row_ror:8 row_mask:0xf bank_mask:0xc
    v_xor_b32 v180, 0x1ab00, v178
    s_waitcnt vmcnt(11)
    buffer_load_dwordx4 v[124:127], v180, s[8:11], 0 offen nt
    v_perm_b32 v51, v140, v136, s29
    v_perm_b32 v55, v140, v136, s30
    v_perm_b32 v59, v141, v137, s29
    v_perm_b32 v63, v141, v137, s30
    v_perm_b32 v67, v142, v138, s29
    v_perm_b32 v71, v142, v138, s30
    v_perm_b32 v75, v143, v139, s29
    v_perm_b32 v79, v143, v139, s30
    v_mfma_f32_16x16x32_bf16 v[80:83], v[48:51], v[16:19], v[80:83]
    v_mfma_f32_16x16x32_bf16 v[84:87], v[52:55], v[16:19], v[84:87]
    v_mfma_f32_16x16x32_bf16 v[88:91], v[56:59], v[16:19], v[88:91]
    v_mfma_f32_16x16x32_bf16 v[92:95], v[60:63], v[16:19], v[92:95]
    v_xor_b32 v179, 0x72b00, v178
    s_waitcnt vmcnt(11)
    buffer_load_dwordx4 v[128:131], v179, s[8:11], 0 offen nt
    v_mfma_f32_16x16x32_bf16 v[96:99], v[64:67], v[16:19], v[96:99]
    v_mfma_f32_16x16x32_bf16 v[100:103], v[68:71], v[16:19], v[100:103]
    v_mfma_f32_16x16x32_bf16 v[104:107], v[72:75], v[16:19], v[104:107]
    v_mfma_f32_16x16x32_bf16 v[108:111], v[76:79], v[16:19], v[108:111]
    v_xor_b32 v180, 0x7a000, v178
    s_waitcnt vmcnt(11)
    buffer_load_dwordx4 v[132:135], v180, s[8:11], 0 offen nt
    v_perm_b32 v48, v148, v144, s29
    v_perm_b32 v52, v148, v144, s30
    v_perm_b32 v56, v149, v145, s29
    v_perm_b32 v60, v149, v145, s30
    v_perm_b32 v64, v150, v146, s29
    v_perm_b32 v68, v150, v146, s30
    v_perm_b32 v72, v151, v147, s29
    v_perm_b32 v76, v151, v147, s30
    v_xor_b32 v179, 0x60b00, v178
    s_waitcnt vmcnt(11)
    buffer_load_dwordx4 v[136:139], v179, s[8:11], 0 offen nt
    v_mov_b32_dpp v12, v12 row_ror:8 row_mask:0xf bank_mask:0x3
    v_mov_b32_dpp v13, v13 row_ror:8 row_mask:0xf bank_mask:0x3
    v_mov_b32_dpp v14, v14 row_ror:8 row_mask:0xf bank_mask:0x3
    v_mov_b32_dpp v15, v15 row_ror:8 row_mask:0xf bank_mask:0x3
    s_add_u32 s31, s33, 1
    s_mov_b32 s25, s24
    s_bitcmp1_b32 s31, 0
    s_cselect_b32 s3, 0x11300, 0
    s_xor_b32 s25, s25, s3
    s_bitcmp1_b32 s31, 1
    s_cselect_b32 s3, 0xc9200, 0
    s_xor_b32 s25, s25, s3
    s_bitcmp1_b32 s31, 2
    s_cselect_b32 s3, 0x4b000, 0
    s_xor_b32 s25, s25, s3
    s_bitcmp1_b32 s31, 3
    s_cselect_b32 s3, 0x94100, 0
    s_xor_b32 s25, s25, s3
    s_bitcmp1_b32 s31, 4
    s_cselect_b32 s3, 0x43f00, 0
    s_xor_b32 s25, s25, s3
    v_xor_b32 v180, 0x68000, v178
    s_waitcnt vmcnt(11)
    buffer_load_dwordx4 v[140:143], v180, s[8:11], 0 offen nt
    v_perm_b32 v49, v156, v152, s29
    v_perm_b32 v53, v156, v152, s30
    v_perm_b32 v57, v157, v153, s29
    v_perm_b32 v61, v157, v153, s30
    v_perm_b32 v65, v158, v154, s29
    v_perm_b32 v69, v158, v154, s30
    v_perm_b32 v73, v159, v155, s29
    v_perm_b32 v77, v159, v155, s30
    v_xor_b32 v179, 0x8800, v178
    s_waitcnt vmcnt(11)
    buffer_load_dwordx4 v[144:147], v179, s[8:11], 0 offen nt
    s_cmp_lg_u32 s26, 1
    s_cbranch_scc1 L_V12_l
    s_call_b64 s[58:59], L_sum
L_V12_l:
    s_sub_u32 s26, s26, 1
    s_cmp_lt_u32 s33, s51
    s_cselect_b32 s60, s52, 10
    s_xor_b32 s60, s60, 12
    s_cmp_eq_u32 s26, 0
    s_cselect_b32 s60, 1, s60
    s_cmp_eq_u32 s33, s50
    s_cselect_b32 s60, 1, s60
    v_xor_b32 v180, 0x300, v178
    s_waitcnt vmcnt(11)
    buffer_load_dwordx4 v[148:151], v180, s[8:11], 0 offen nt
    v_perm_b32 v50, v164, v160, s29
    v_perm_b32 v54, v164, v160, s30
    v_perm_b32 v58, v165, v161, s29
    v_perm_b32 v62, v165, v161, s30
    v_perm_b32 v66, v166, v162, s29
    v_perm_b32 v70, v166, v162, s30
    v_perm_b32 v74, v167, v163, s29
    v_perm_b32 v78, v167, v163, s30
    v_xor_b32 v179, 0x1a800, v178
    s_waitcnt vmcnt(11)
    buffer_load_dwordx4 v[152:155], v179, s[8:11], 0 offen nt
    s_waitcnt lgkmcnt(1)
    v_sub_f32 v24, v24, v5
    v_sub_f32 v25, v25, v5
    v_sub_f32 v26, v26, v5
    v_sub_f32 v27, v27, v5
    v_sub_f32 v28, v28, v5
    v_sub_f32 v29, v29, v5
    v_sub_f32 v30, v30, v5
    v_sub_f32 v31, v31, v5
    v_mul_f32 v24, s28, v24
    v_mul_f32 v25, s28, v25
    v_mul_f32 v26, s28, v26
    v_mul_f32 v27, s28, v27
    v_mul_f32 v28, s28, v28
    v_mul_f32 v29, s28, v29
    v_mul_f32 v30, s28, v30
    v_mul_f32 v31, s28, v31
    v_xor_b32 v180, 0x12300, v178
    s_waitcnt vmcnt(11)
    buffer_load_dwordx4 v[156:159], v180, s[8:11], 0 offen nt
    v_perm_b32 v51, v172, v168, s29
    v_perm_b32 v55, v172, v168, s30
    v_perm_b32 v59, v173, v169, s29
    v_perm_b32 v63, v173, v169, s30
    v_perm_b32 v67, v174, v170, s29
    v_perm_b32 v71, v174, v170, s30
    v_perm_b32 v75, v175, v171, s29
    v_perm_b32 v79, v175, v171, s30
    v_mfma_f32_16x16x32_bf16 v[80:83], v[48:51], v[12:15], v[80:83]
    v_mfma_f32_16x16x32_bf16 v[84:87], v[52:55], v[12:15], v[84:87]
    v_mfma_f32_16x16x32_bf16 v[88:91], v[56:59], v[12:15], v[88:91]
    v_mfma_f32_16x16x32_bf16 v[92:95], v[60:63], v[12:15], v[92:95]
    v_mfma_f32_16x16x32_bf16 v[96:99], v[64:67], v[12:15], v[96:99]
    v_mfma_f32_16x16x32_bf16 v[100:103], v[68:71], v[12:15], v[100:103]
    v_mfma_f32_16x16x32_bf16 v[104:107], v[72:75], v[12:15], v[104:107]
    v_mfma_f32_16x16x32_bf16 v[108:111], v[76:79], v[12:15], v[108:111]
    s_cmp_eq_u32 s60, 0
    s_cbranch_scc1 L_V12
    s_cmp_eq_u32 s26, 0
    s_cbranch_scc1 L_epi
    s_cmp_lg_u32 s33, s50
    s_cbranch_scc1 L_V12_c
    s_call_b64 s[58:59], L_ctl
L_V12_c:
    s_cmp_lt_u32 s33, s51
    s_cselect_b32 s32, s52, 10
    s_cmp_ge_u32 s32, 12
    s_cbranch_scc1 L_V12
    s_waitcnt vmcnt(11)
    s_branch L_V11_a
L_T11:
    v_subrev_u32 v7, 65536, v7
    ds_read_b128 v[24:27], v7
    ds_read_b128 v[28:31], v7 offset:1024
    ds_read_b32 v189, v7
    v_max_f32_dpp v5, v5, v5 row_ror:8 row_mask:0xf bank_mask:0xf
    s_mov_b32 s26, 32
    v_mov_b32 v4, v5
    s_nop 1
    v_permlane32_swap_b32 v5, v4
    v_max_f32 v5, v5, v4
    v_mov_b32 v4, v5
    s_nop 1
    v_permlane16_swap_b32 v5, v4
    v_max_f32 v5, v5, v4
    s_waitcnt lgkmcnt(1)
    v_sub_f32 v24, v24, v5
    v_sub_f32 v25, v25, v5
    v_sub_f32 v26, v26, v5
    v_sub_f32 v27, v27, v5
    v_sub_f32 v28, v28, v5
    v_sub_f32 v29, v29, v5
    v_sub_f32 v30, v30, v5
    v_sub_f32 v31, v31, v5
    v_mul_f32 v24, s28, v24
    v_mul_f32 v25, s28, v25
    v_mul_f32 v26, s28, v26
    v_mul_f32 v27, s28, v27
    v_mul_f32 v28, s28, v28
    v_mul_f32 v29, s28, v29
    v_mul_f32 v30, s28, v30
    v_mul_f32 v31, s28, v31
.p2align 3
L_V11:
    v_xor_b32 v180, 0x12300, v178
    s_waitcnt vmcnt(10)
    buffer_load_dwordx4 v[156:159], v180, s[8:11], 0 offen nt
L_V11_a:
    v_xor_b32 v179, 0x7a300, v178
    buffer_load_dwordx4 v[160:163], v179, s[8:11], 0 offen nt
    s_add_u32 s33, s33, 1
    v_exp_f32 v24, v24
    v_exp_f32 v25, v25
    v_exp_f32 v26, v26
    v_exp_f32 v27, v27
    v_exp_f32 v28, v28
    v_xor_b32 v180, 0x72800, v178
    s_waitcnt vmcnt(11)
    buffer_load_dwordx4 v[164:167], v180, s[8:11], 0 offen nt
    v_perm_b32 v48, v116, v112, s29
    v_perm_b32 v52, v116, v112, s30
    v_perm_b32 v56, v117, v113, s29
    v_perm_b32 v60, v117, v113, s30
    v_perm_b32 v64, v118, v114, s29
    v_perm_b32 v68, v118, v114, s30
    v_perm_b32 v72, v119, v115, s29
    v_perm_b32 v76, v119, v115, s30
    v_xor_b32 v179, 0x68300, v178
    s_waitcnt vmcnt(11)
    buffer_load_dwordx4 v[168:171], v179, s[8:11], 0 offen nt
    v_exp_f32 v29, v29
    v_exp_f32 v30, v30
    v_exp_f32 v31, v31
    v_add_f32 v3, v24, v25
    v_add_f32 v4, v26, v27
    v_xor_b32 v180, 0x60800, v178
    s_waitcnt vmcnt(11)
    buffer_load_dwordx4 v[172:175], v180, s[8:11], 0 offen nt
    v_perm_b32 v49, v124, v120, s29
    v_perm_b32 v53, v124, v120, s30
    v_perm_b32 v57, v125, v121, s29
    v_perm_b32 v61, v125, v121, s30
    v_perm_b32 v65, v126, v122, s29
    v_perm_b32 v69, v126, v122, s30
    v_perm_b32 v73, v127, v123, s29
    v_perm_b32 v77, v127, v123, s30
    s_cmp_eq_u32 s26, 1
    s_cselect_b32 s10, 0, s10
    v_xor_b32 v178, s25, v1
    s_waitcnt vmcnt(11)
    buffer_load_dwordx4 v[112:115], v178, s[8:11], 0 offen nt
    v_cvt_pk_bf16_f32 v16, v24, v25
    v_cvt_pk_bf16_f32 v17, v26, v27
    v_cvt_pk_bf16_f32 v18, v28, v29
    v_cvt_pk_bf16_f32 v19, v30, v31
    v_cvt_pk_bf16_f32 v12, v24, v25
    v_cvt_pk_bf16_f32 v13, v26, v27
    v_cvt_pk_bf16_f32 v14, v28, v29
    v_cvt_pk_bf16_f32 v15, v30, v31
    v_add_f32 v3, v3, v28
    v_add_f32 v4, v4, v29
    v_add_f32 v3, v3, v30
    v_add_f32 v4, v4, v31
    v_add_f32 v6, v6, v3
    v_add_f32 v6, v6, v4
    v_xor_b32 v180, 0x8b00, v178
    s_waitcnt vmcnt(11)
    buffer_load_dwordx4 v[116:119], v180, s[8:11], 0 offen nt
    v_perm_b32 v50, v132, v128, s29
    v_perm_b32 v54, v132, v128, s30
    v_perm_b32 v58, v133, v129, s29
    v_perm_b32 v62, v133, v129, s30
    v_perm_b32 v66, v134, v130, s29
    v_perm_b32 v70, v134, v130, s30
    v_perm_b32 v74, v135, v131, s29
    v_perm_b32 v78, v135, v131, s30
    s_waitcnt vmcnt(11)
    v_add_u32 v7, 2048, v7
    ds_read_b128 v[24:27], v7
    ds_read_b128 v[28:31], v7 offset:1024
    ds_read_b32 v189, v7
    v_mov_b32_dpp v16, v16 row_ror:8 row_mask:0xf bank_mask:0xc
    v_mov_b32_dpp v17, v17 row_ror:8 row_mask:0xf bank_mask:0xc
    v_mov_b32_dpp v18, v18 row_ror:8 row_mask:0xf bank_mask:0xc
    v_mov_b32_dpp v19, v19 row_ror:8 row_mask:0xf bank_mask:0xc
    v_xor_b32 v179, 0x12000, v178
    s_waitcnt vmcnt(10)
    buffer_load_dwordx4 v[120:123], v179, s[8:11], 0 offen nt
    v_perm_b32 v51, v140, v136, s29
    v_perm_b32 v55, v140, v136, s30
    v_perm_b32 v59, v141, v137, s29
    v_perm_b32 v63, v141, v137, s30
    v_perm_b32 v67, v142, v138, s29
    v_perm_b32 v71, v142, v138, s30
    v_perm_b32 v75, v143, v139, s29
    v_perm_b32 v79, v143, v139, s30
    v_mfma_f32_16x16x32_bf16 v[80:83], v[48:51], v[16:19], v[80:83]
    v_mfma_f32_16x16x32_bf16 v[84:87], v[52:55], v[16:19], v[84:87]
    v_mfma_f32_16x16x32_bf16 v[88:91], v[56:59], v[16:19], v[88:91]
    v_mfma_f32_16x16x32_bf16 v[92:95], v[60:63], v[16:19], v[92:95]
    v_xor_b32 v180, 0x1ab00, v178
    s_waitcnt vmcnt(10)
    buffer_load_dwordx4 v[124:127], v180, s[8:11], 0 offen nt
    v_mfma_f32_16x16x32_bf16 v[96:99], v[64:67], v[16:19], v[96:99]
    v_mfma_f32_16x16x32_bf16 v[100:103], v[68:71], v[16:19], v[100:103]
    v_mfma_f32_16x16x32_bf16 v[104:107], v[72:75], v[16:19], v[104:107]
    v_mfma_f32_16x16x32_bf16 v[108:111], v[76:79], v[16:19], v[108:111]
    v_xor_b32 v179, 0x72b00, v178
    s_waitcnt vmcnt(10)
    buffer_load_dwordx4 v[128:131], v179, s[8:11], 0 offen nt
    v_perm_b32 v48, v148, v144, s29
    v_perm_b32 v52, v148, v144, s30
    v_perm_b32 v56, v149, v145, s29
    v_perm_b32 v60, v149, v145, s30
    v_perm_b32 v64, v150, v146, s29
    v_perm_b32 v68, v150, v146, s30
    v_perm_b32 v72, v151, v147, s29
    v_perm_b32 v76, v151, v147, s30
    v_xor_b32 v180, 0x7a000, v178
    s_waitcnt vmcnt(10)
    buffer_load_dwordx4 v[132:135], v180, s[8:11], 0 offen nt
    v_mov_b32_dpp v12, v12 row_ror:8 row_mask:0xf bank_mask:0x3
    v_mov_b32_dpp v13, v13 row_ror:8 row_mask:0xf bank_mask:0x3
    v_mov_b32_dpp v14, v14 row_ror:8 row_mask:0xf bank_mask:0x3
    v_mov_b32_dpp v15, v15 row_ror:8 row_mask:0xf bank_mask:0x3
    s_add_u32 s31, s33, 1
    s_mov_b32 s25, s24
    s_bitcmp1_b32 s31, 0
    s_cselect_b32 s3, 0x11300, 0
    s_xor_b32 s25, s25, s3
    s_bitcmp1_b32 s31, 1
    s_cselect_b32 s3, 0xc9200, 0
    s_xor_b32 s25, s25, s3
    s_bitcmp1_b32 s31, 2
    s_cselect_b32 s3, 0x4b000, 0
    s_xor_b32 s25, s25, s3
    s_bitcmp1_b32 s31, 3
    s_cselect_b32 s3, 0x94100, 0
    s_xor_b32 s25, s25, s3
    s_bitcmp1_b32 s31, 4
    s_cselect_b32 s3, 0x43f00, 0
    s_xor_b32 s25, s25, s3
    v_xor_b32 v179, 0x60b00, v178
    s_waitcnt vmcnt(10)
    buffer_load_dwordx4 v[136:139], v179, s[8:11], 0 offen nt
    v_perm_b32 v49, v156, v152, s29
    v_perm_b32 v53, v156, v152, s30
    v_perm_b32 v57, v157, v153, s29
    v_perm_b32 v61, v157, v153, s30
    v_perm_b32 v65, v158, v154, s29
    v_perm_b32 v69, v158, v154, s30
    v_perm_b32 v73, v159, v155, s29
    v_perm_b32 v77, v159, v155, s30
    v_xor_b32 v180, 0x68000, v178
    s_waitcnt vmcnt(10)
    buffer_load_dwordx4 v[140:143], v180, s[8:11], 0 offen nt
    s_cmp_lg_u32 s26, 1
    s_cbranch_scc1 L_V11_l
    s_call_b64 s[58:59], L_sum
L_V11_l:
    s_sub_u32 s26, s26, 1
    s_cmp_lt_u32 s33, s51
    s_cselect_b32 s60, s52, 10
    s_xor_b32 s60, s60, 11
    s_cmp_eq_u32 s26, 0
    s_cselect_b32 s60, 1, s60
    s_cmp_eq_u32 s33, s50
    s_cselect_b32 s60, 1, s60
    v_xor_b32 v179, 0x8800, v178
    s_waitcnt vmcnt(10)
    buffer_load_dwordx4 v[144:147], v179, s[8:11], 0 offen nt
    v_perm_b32 v50, v164, v160, s29
    v_perm_b32 v54, v164, v160, s30
    v_perm_b32 v58, v165, v161, s29
    v_perm_b32 v62, v165, v161, s30
    v_perm_b32 v66, v166, v162, s29
    v_perm_b32 v70, v166, v162, s30
    v_perm_b32 v74, v167, v163, s29
    v_perm_b32 v78, v167, v163, s30
    v_xor_b32 v180, 0x300, v178
    s_waitcnt vmcnt(10)
    buffer_load_dwordx4 v[148:151], v180, s[8:11], 0 offen nt
    s_waitcnt lgkmcnt(1)
    v_sub_f32 v24, v24, v5
    v_sub_f32 v25, v25, v5
    v_sub_f32 v26, v26, v5
    v_sub_f32 v27, v27, v5
    v_sub_f32 v28, v28, v5
    v_sub_f32 v29, v29, v5
    v_sub_f32 v30, v30, v5
    v_sub_f32 v31, v31, v5
    v_mul_f32 v24, s28, v24
    v_mul_f32 v25, s28, v25
    v_mul_f32 v26, s28, v26
    v_mul_f32 v27, s28, v27
    v_mul_f32 v28, s28, v28
    v_mul_f32 v29, s28, v29
    v_mul_f32 v30, s28, v30
    v_mul_f32 v31, s28, v31
    v_xor_b32 v179, 0x1a800, v178
    s_waitcnt vmcnt(10)
    buffer_load_dwordx4 v[152:155], v179, s[8:11], 0 offen nt
    v_perm_b32 v51, v172, v168, s29
    v_perm_b32 v55, v172, v168, s30
    v_perm_b32 v59, v173, v169, s29
    v_perm_b32 v63, v173, v169, s30
    v_perm_b32 v67, v174, v170, s29
    v_perm_b32 v71, v174, v170, s30
    v_perm_b32 v75, v175, v171, s29
    v_perm_b32 v79, v175, v171, s30
    v_mfma_f32_16x16x32_bf16 v[80:83], v[48:51], v[12:15], v[80:83]
    v_mfma_f32_16x16x32_bf16 v[84:87], v[52:55], v[12:15], v[84:87]
    v_mfma_f32_16x16x32_bf16 v[88:91], v[56:59], v[12:15], v[88:91]
    v_mfma_f32_16x16x32_bf16 v[92:95], v[60:63], v[12:15], v[92:95]
    v_mfma_f32_16x16x32_bf16 v[96:99], v[64:67], v[12:15], v[96:99]
    v_mfma_f32_16x16x32_bf16 v[100:103], v[68:71], v[12:15], v[100:103]
    v_mfma_f32_16x16x32_bf16 v[104:107], v[72:75], v[12:15], v[104:107]
    v_mfma_f32_16x16x32_bf16 v[108:111], v[76:79], v[12:15], v[108:111]
    s_cmp_eq_u32 s60, 0
    s_cbranch_scc1 L_V11
    s_cmp_eq_u32 s26, 0
    s_cbranch_scc1 L_epi
    s_cmp_lg_u32 s33, s50
    s_cbranch_scc1 L_V11_c
    s_call_b64 s[58:59], L_ctl
L_V11_c:
    s_cmp_lt_u32 s33, s51
    s_cselect_b32 s32, s52, 10
    s_cmp_gt_u32 s32, 11
    s_cbranch_scc1 L_V11_up
    s_cmp_ge_u32 s32, 11
    s_cbranch_scc1 L_V11
    s_waitcnt vmcnt(10)
    s_branch L_V10_a
L_V11_up:
    v_xor_b32 v180, 0x12300, v178
    buffer_load_dwordx4 v[156:159], v180, s[8:11], 0 offen nt
    s_branch L_V12
L_T9:
    v_subrev_u32 v7, 65536, v7
    ds_read_b128 v[24:27], v7
    ds_read_b128 v[28:31], v7 offset:1024
    ds_read_b32 v189, v7
    v_max_f32_dpp v5, v5, v5 row_ror:8 row_mask:0xf bank_mask:0xf
    s_mov_b32 s26, 32
    v_mov_b32 v4, v5
    s_nop 1
    v_permlane32_swap_b32 v5, v4
    v_max_f32 v5, v5, v4
    v_mov_b32 v4, v5
    s_nop 1
    v_permlane16_swap_b32 v5, v4
    v_max_f32 v5, v5, v4
    s_waitcnt lgkmcnt(1)
    v_sub_f32 v24, v24, v5
    v_sub_f32 v25, v25, v5
    v_sub_f32 v26, v26, v5
    v_sub_f32 v27, v27, v5
    v_sub_f32 v28, v28, v5
    v_sub_f32 v29, v29, v5
    v_sub_f32 v30, v30, v5
    v_sub_f32 v31, v31, v5
    v_mul_f32 v24, s28, v24
    v_mul_f32 v25, s28, v25
    v_mul_f32 v26, s28, v26
    v_mul_f32 v27, s28, v27
    v_mul_f32 v28, s28, v28
    v_mul_f32 v29, s28, v29
    v_mul_f32 v30, s28, v30
    v_mul_f32 v31, s28, v31
.p2align 3
L_V9:
    v_xor_b32 v180, 0x300, v178
    s_waitcnt vmcnt(8)
    buffer_load_dwordx4 v[148:151], v180, s[8:11], 0 offen nt
L_V9_a:
    v_xor_b32 v179, 0x1a800, v178
    buffer_load_dwordx4 v[152:155], v179, s[8:11], 0 offen nt
    s_add_u32 s33, s33, 1
    v_exp_f32 v24, v24
    v_exp_f32 v25, v25
    v_exp_f32 v26, v26
    v_exp_f32 v27, v27
    v_exp_f32 v28, v28
    v_xor_b32 v180, 0x12300, v178
    s_waitcnt vmcnt(9)
    buffer_load_dwordx4 v[156:159], v180, s[8:11], 0 offen nt
    v_perm_b32 v48, v116, v112, s29
    v_perm_b32 v52, v116, v112, s30
    v_perm_b32 v56, v117, v113, s29
    v_perm_b32 v60, v117, v113, s30
    v_perm_b32 v64, v118, v114, s29
    v_perm_b32 v68, v118, v114, s30
    v_perm_b32 v72, v119, v115, s29
    v_perm_b32 v76, v119, v115, s30
    v_xor_b32 v179, 0x7a300, v178
    s_waitcnt vmcnt(9)
    buffer_load_dwordx4 v[160:163], v179, s[8:11], 0 offen nt
    v_exp_f32 v29, v29
    v_exp_f32 v30, v30
    v_exp_f32 v31, v31
    v_add_f32 v3, v24, v25
    v_add_f32 v4, v26, v27
    v_xor_b32 v180, 0x72800, v178
    s_waitcnt vmcnt(9)
    buffer_load_dwordx4 v[164:167], v180, s[8:11], 0 offen nt
    v_perm_b32 v49, v124, v120, s29
    v_perm_b32 v53, v124, v120, s30
    v_perm_b32 v57, v125, v121, s29
    v_perm_b32 v61, v125, v121, s30
    v_perm_b32 v65, v126, v122, s29
    v_perm_b32 v69, v126, v122, s30
    v_perm_b32 v73, v127, v123, s29
    v_perm_b32 v77, v127, v123, s30
    v_xor_b32 v179, 0x68300, v178
    s_waitcnt vmcnt(9)
    buffer_load_dwordx4 v[168:171], v179, s[8:11], 0 offen nt
    v_cvt_pk_bf16_f32 v16, v24, v25
    v_cvt_pk_bf16_f32 v17, v26, v27
    v_cvt_pk_bf16_f32 v18, v28, v29
    v_cvt_pk_bf16_f32 v19, v30, v31
    v_cvt_pk_bf16_f32 v12, v24, v25
    v_cvt_pk_bf16_f32 v13, v26, v27
    v_cvt_pk_bf16_f32 v14, v28, v29
    v_cvt_pk_bf16_f32 v15, v30, v31
    v_add_f32 v3, v3, v28
    v_add_f32 v4, v4, v29
    v_add_f32 v3, v3, v30
    v_add_f32 v4, v4, v31
    v_add_f32 v6, v6, v3
    v_add_f32 v6, v6, v4
    v_xor_b32 v180, 0x60800, v178
    s_waitcnt vmcnt(9)
    buffer_load_dwordx4 v[172:175], v180, s[8:11], 0 offen nt
    v_perm_b32 v50, v132, v128, s29
    v_perm_b32 v54, v132, v128, s30
    v_perm_b32 v58, v133, v129, s29
    v_perm_b32 v62, v133, v129, s30
    v_perm_b32 v66, v134, v130, s29
    v_perm_b32 v70, v134, v130, s30
    v_perm_b32 v74, v135, v131, s29
    v_perm_b32 v78, v135, v131, s30
    s_waitcnt vmcnt(9)
    v_add_u32 v7, 2048, v7
    ds_read_b128 v[24:27], v7
    ds_read_b128 v[28:31], v7 offset:1024
    ds_read_b32 v189, v7
    v_mov_b32_dpp v16, v16 row_ror:8 row_mask:0xf bank_mask:0xc
    v_mov_b32_dpp v17, v17 row_ror:8 row_mask:0xf bank_mask:0xc
    v_mov_b32_dpp v18, v18 row_ror:8 row_mask:0xf bank_mask:0xc
    v_mov_b32_dpp v19, v19 row_ror:8 row_mask:0xf bank_mask:0xc
    s_cmp_eq_u32 s26, 1
    s_cselect_b32 s10, 0, s10
    v_xor_b32 v178, s25, v1
    s_waitcnt vmcnt(8)
    buffer_load_dwordx4 v[112:115], v178, s[8:11], 0 offen nt
    v_perm_b32 v51, v140, v136, s29
    v_perm_b32 v55, v140, v136, s30
    v_perm_b32 v59, v141, v137, s29
    v_perm_b32 v63, v141, v137, s30
    v_perm_b32 v67, v142, v138, s29
    v_perm_b32 v71, v142, v138, s30
    v_perm_b32 v75, v143, v139, s29
    v_perm_b32 v79, v143, v139, s30
    v_mfma_f32_16x16x32_bf16 v[80:83], v[48:51], v[16:19], v[80:83]
    v_mfma_f32_16x16x32_bf16 v[84:87], v[52:55], v[16:19], v[84:87]
    v_mfma_f32_16x16x32_bf16 v[88:91], v[56:59], v[16:19], v[88:91]
    v_mfma_f32_16x16x32_bf16 v[92:95], v[60:63], v[16:19], v[92:95]
    v_xor_b32 v180, 0x8b00, v178
    s_waitcnt vmcnt(8)
    buffer_load_dwordx4 v[116:119], v180, s[8:11], 0 offen nt
    v_mfma_f32_16x16x32_bf16 v[96:99], v[64:67], v[16:19], v[96:99]
    v_mfma_f32_16x16x32_bf16 v[100:103], v[68:71], v[16:19], v[100:103]
    v_mfma_f32_16x16x32_bf16 v[104:107], v[72:75], v[16:19], v[104:107]
    v_mfma_f32_16x16x32_bf16 v[108:111], v[76:79], v[16:19], v[108:111]
    v_xor_b32 v179, 0x12000, v178
    s_waitcnt vmcnt(8)
    buffer_load_dwordx4 v[120:123], v179, s[8:11], 0 offen nt
    v_perm_b32 v48, v148, v144, s29
    v_perm_b32 v52, v148, v144, s30
    v_perm_b32 v56, v149, v145, s29
    v_perm_b32 v60, v149, v145, s30
    v_perm_b32 v64, v150, v146, s29
    v_perm_b32 v68, v150, v146, s30
    v_perm_b32 v72, v151, v147, s29
    v_perm_b32 v76, v151, v147, s30
    v_xor_b32 v180, 0x1ab00, v178
    s_waitcnt vmcnt(8)
    buffer_load_dwordx4 v[124:127], v180, s[8:11], 0 offen nt
    v_mov_b32_dpp v12, v12 row_ror:8 row_mask:0xf bank_mask:0x3
    v_mov_b32_dpp v13, v13 row_ror:8 row_mask:0xf bank_mask:0x3
    v_mov_b32_dpp v14, v14 row_ror:8 row_mask:0xf bank_mask:0x3
    v_mov_b32_dpp v15, v15 row_ror:8 row_mask:0xf bank_mask:0x3
    s_add_u32 s31, s33, 1
    s_mov_b32 s25, s24
    s_bitcmp1_b32 s31, 0
    s_cselect_b32 s3, 0x11300, 0
    s_xor_b32 s25, s25, s3
    s_bitcmp1_b32 s31, 1
    s_cselect_b32 s3, 0xc9200, 0
    s_xor_b32 s25, s25, s3
    s_bitcmp1_b32 s31, 2
    s_cselect_b32 s3, 0x4b000, 0
    s_xor_b32 s25, s25, s3
    s_bitcmp1_b32 s31, 3
    s_cselect_b32 s3, 0x94100, 0
    s_xor_b32 s25, s25, s3
    s_bitcmp1_b32 s31, 4
    s_cselect_b32 s3, 0x43f00, 0
    s_xor_b32 s25, s25, s3
    v_xor_b32 v179, 0x72b00, v178
    s_waitcnt vmcnt(8)
    buffer_load_dwordx4 v[128:131], v179, s[8:11], 0 offen nt
    v_perm_b32 v49, v156, v152, s29
    v_perm_b32 v53, v156, v152, s30
    v_perm_b32 v57, v157, v153, s29
    v_perm_b32 v61, v157, v153, s30
    v_perm_b32 v65, v158, v154, s29
    v_perm_b32 v69, v158, v154, s30
    v_perm_b32 v73, v159, v155, s29
    v_perm_b32 v77, v159, v155, s30
    v_xor_b32 v180, 0x7a000, v178
    s_waitcnt vmcnt(8)
    buffer_load_dwordx4 v[132:135], v180, s[8:11], 0 offen nt
    s_cmp_lg_u32 s26, 1
    s_cbranch_scc1 L_V9_l
    s_call_b64 s[58:59], L_sum
L_V9_l:
    s_sub_u32 s26, s26, 1
    s_cmp_lt_u32 s33, s51
    s_cselect_b32 s60, s52, 10
    s_xor_b32 s60, s60, 9
    s_cmp_eq_u32 s26, 0
    s_cselect_b32 s60, 1, s60
    s_cmp_eq_u32 s33, s50
    s_cselect_b32 s60, 1, s60
    v_xor_b32 v179, 0x60b00, v178
    s_waitcnt vmcnt(8)
    buffer_load_dwordx4 v[136:139], v179, s[8:11], 0 offen nt
    v_perm_b32 v50, v164, v160, s29
    v_perm_b32 v54, v164, v160, s30
    v_perm_b32 v58, v165, v161, s29
    v_perm_b32 v62, v165, v161, s30
    v_perm_b32 v66, v166, v162, s29
    v_perm_b32 v70, v166, v162, s30
    v_perm_b32 v74, v167, v163, s29
    v_perm_b32 v78, v167, v163, s30
    v_xor_b32 v180, 0x68000, v178
    s_waitcnt vmcnt(8)
    buffer_load_dwordx4 v[140:143], v180, s[8:11], 0 offen nt
    s_waitcnt lgkmcnt(1)
    v_sub_f32 v24, v24, v5
    v_sub_f32 v25, v25, v5
    v_sub_f32 v26, v26, v5
    v_sub_f32 v27, v27, v5
    v_sub_f32 v28, v28, v5
    v_sub_f32 v29, v29, v5
    v_sub_f32 v30, v30, v5
    v_sub_f32 v31, v31, v5
    v_mul_f32 v24, s28, v24
    v_mul_f32 v25, s28, v25
    v_mul_f32 v26, s28, v26
    v_mul_f32 v27, s28, v27
    v_mul_f32 v28, s28, v28
    v_mul_f32 v29, s28, v29
    v_mul_f32 v30, s28, v30
    v_mul_f32 v31, s28, v31
    v_xor_b32 v179, 0x8800, v178
    s_waitcnt vmcnt(8)
    buffer_load_dwordx4 v[144:147], v179, s[8:11], 0 offen nt
    v_perm_b32 v51, v172, v168, s29
    v_perm_b32 v55, v172, v168, s30
    v_perm_b32 v59, v173, v169, s29
    v_perm_b32 v63, v173, v169, s30
    v_perm_b32 v67, v174, v170, s29
    v_perm_b32 v71, v174, v170, s30
    v_perm_b32 v75, v175, v171, s29
    v_perm_b32 v79, v175, v171, s30
    v_mfma_f32_16x16x32_bf16 v[80:83], v[48:51], v[12:15], v[80:83]
    v_mfma_f32_16x16x32_bf16 v[84:87], v[52:55], v[12:15], v[84:87]
    v_mfma_f32_16x16x32_bf16 v[88:91], v[56:59], v[12:15], v[88:91]
    v_mfma_f32_16x16x32_bf16 v[92:95], v[60:63], v[12:15], v[92:95]
    v_mfma_f32_16x16x32_bf16 v[96:99], v[64:67], v[12:15], v[96:99]
    v_mfma_f32_16x16x32_bf16 v[100:103], v[68:71], v[12:15], v[100:103]
    v_mfma_f32_16x16x32_bf16 v[104:107], v[72:75], v[12:15], v[104:107]
    v_mfma_f32_16x16x32_bf16 v[108:111], v[76:79], v[12:15], v[108:111]
    s_cmp_eq_u32 s60, 0
    s_cbranch_scc1 L_V9
    s_cmp_eq_u32 s26, 0
    s_cbranch_scc1 L_epi
    s_cmp_lg_u32 s33, s50
    s_cbranch_scc1 L_V9_c
    s_call_b64 s[58:59], L_ctl
L_V9_c:
    s_cmp_lt_u32 s33, s51
    s_cselect_b32 s32, s52, 10
    s_cmp_gt_u32 s32, 9
    s_cbranch_scc1 L_V9_up
    s_cmp_ge_u32 s32, 9
    s_cbranch_scc1 L_V9
    s_waitcnt vmcnt(8)
    s_branch L_V8_a
L_V9_up:
    v_xor_b32 v180, 0x300, v178
    buffer_load_dwordx4 v[148:151], v180, s[8:11], 0 offen nt
    s_branch L_V10
L_T8:
    v_subrev_u32 v7, 65536, v7
    ds_read_b128 v[24:27], v7
    ds_read_b128 v[28:31], v7 offset:1024
    ds_read_b32 v189, v7
    v_max_f32_dpp v5, v5, v5 row_ror:8 row_mask:0xf bank_mask:0xf
    s_mov_b32 s26, 32
    v_mov_b32 v4, v5
    s_nop 1
    v_permlane32_swap_b32 v5, v4
    v_max_f32 v5, v5, v4
    v_mov_b32 v4, v5
    s_nop 1
    v_permlane16_swap_b32 v5, v4
    v_max_f32 v5, v5, v4
    s_waitcnt lgkmcnt(1)
    v_sub_f32 v24, v24, v5
    v_sub_f32 v25, v25, v5
    v_sub_f32 v26, v26, v5
    v_sub_f32 v27, v27, v5
    v_sub_f32 v28, v28, v5
    v_sub_f32 v29, v29, v5
    v_sub_f32 v30, v30, v5
    v_sub_f32 v31, v31, v5
    v_mul_f32 v24, s28, v24
    v_mul_f32 v25, s28, v25
    v_mul_f32 v26, s28, v26
    v_mul_f32 v27, s28, v27
    v_mul_f32 v28, s28, v28
    v_mul_f32 v29, s28, v29
    v_mul_f32 v30, s28, v30
    v_mul_f32 v31, s28, v31
.p2align 3
L_V8:
    v_xor_b32 v179, 0x8800, v178
    s_waitcnt vmcnt(7)
    buffer_load_dwordx4 v[144:147], v179, s[8:11], 0 offen nt
L_V8_a:
    v_xor_b32 v180, 0x300, v178
    buffer_load_dwordx4 v[148:151], v180, s[8:11], 0 offen nt
    s_add_u32 s33, s33, 1
    v_exp_f32 v24, v24
    v_exp_f32 v25, v25
    v_exp_f32 v26, v26
    v_exp_f32 v27, v27
    v_exp_f32 v28, v28
    v_xor_b32 v179, 0x1a800, v178
    s_waitcnt vmcnt(8)
    buffer_load_dwordx4 v[152:155], v179, s[8:11], 0 offen nt
    v_perm_b32 v48, v116, v112, s29
    v_perm_b32 v52, v116, v112, s30
    v_perm_b32 v56, v117, v113, s29
    v_perm_b32 v60, v117, v113, s30
    v_perm_b32 v64, v118, v114, s29
    v_perm_b32 v68, v118, v114, s30
    v_perm_b32 v72, v119, v115, s29
    v_perm_b32 v76, v119, v115, s30
    v_xor_b32 v180, 0x12300, v178
    s_waitcnt vmcnt(8)
    buffer_load_dwordx4 v[156:159], v180, s[8:11], 0 offen nt
    v_exp_f32 v29, v29
    v_exp_f32 v30, v30
    v_exp_f32 v31, v31
    v_add_f32 v3, v24, v25
    v_add_f32 v4, v26, v27
    v_xor_b32 v179, 0x7a300, v178
    s_waitcnt vmcnt(8)
    buffer_load_dwordx4 v[160:163], v179, s[8:11], 0 offen nt
    v_perm_b32 v49, v124, v120, s29
    v_perm_b32 v53, v124, v120, s30
    v_perm_b32 v57, v125, v121, s29
    v_perm_b32 v61, v125, v121, s30
    v_perm_b32 v65, v126, v122, s29
    v_perm_b32 v69, v126, v122, s30
    v_perm_b32 v73, v127, v123, s29
    v_perm_b32 v77, v127, v123, s30
    v_xor_b32 v180, 0x72800, v178
    s_waitcnt vmcnt(8)
    buffer_load_dwordx4 v[164:167], v180, s[8:11], 0 offen nt
    v_cvt_pk_bf16_f32 v16, v24, v25
    v_cvt_pk_bf16_f32 v17, v26, v27
    v_cvt_pk_bf16_f32 v18, v28, v29
    v_cvt_pk_bf16_f32 v19, v30, v31
    v_cvt_pk_bf16_f32 v12, v24, v25
    v_cvt_pk_bf16_f32 v13, v26, v27
    v_cvt_pk_bf16_f32 v14, v28, v29
    v_cvt_pk_bf16_f32 v15, v30, v31
    v_add_f32 v3, v3, v28
    v_add_f32 v4, v4, v29
    v_add_f32 v3, v3, v30
    v_add_f32 v4, v4, v31
    v_add_f32 v6, v6, v3
    v_add_f32 v6, v6, v4
    v_xor_b32 v179, 0x68300, v178
    s_waitcnt vmcnt(8)
    buffer_load_dwordx4 v[168:171], v179, s[8:11], 0 offen nt
    v_perm_b32 v50, v132, v128, s29
    v_perm_b32 v54, v132, v128, s30
    v_perm_b32 v58, v133, v129, s29
    v_perm_b32 v62, v133, v129, s30
    v_perm_b32 v66, v134, v130, s29
    v_perm_b32 v70, v134, v130, s30
    v_perm_b32 v74, v135, v131, s29
    v_perm_b32 v78, v135, v131, s30
    s_waitcnt vmcnt(8)
    v_add_u32 v7, 2048, v7
    ds_read_b128 v[24:27], v7
    ds_read_b128 v[28:31], v7 offset:1024
    ds_read_b32 v189, v7
    v_mov_b32_dpp v16, v16 row_ror:8 row_mask:0xf bank_mask:0xc
    v_mov_b32_dpp v17, v17 row_ror:8 row_mask:0xf bank_mask:0xc
    v_mov_b32_dpp v18, v18 row_ror:8 row_mask:0xf bank_mask:0xc
    v_mov_b32_dpp v19, v19 row_ror:8 row_mask:0xf bank_mask:0xc
    v_xor_b32 v180, 0x60800, v178
    s_waitcnt vmcnt(7)
    buffer_load_dwordx4 v[172:175], v180, s[8:11], 0 offen nt
    v_perm_b32 v51, v140, v136, s29
    v_perm_b32 v55, v140, v136, s30
    v_perm_b32 v59, v141, v137, s29
    v_perm_b32 v63, v141, v137, s30
    v_perm_b32 v67, v142, v138, s29
    v_perm_b32 v71, v142, v138, s30
    v_perm_b32 v75, v143, v139, s29
    v_perm_b32 v79, v143, v139, s30
    v_mfma_f32_16x16x32_bf16 v[80:83], v[48:51], v[16:19], v[80:83]
    v_mfma_f32_16x16x32_bf16 v[84:87], v[52:55], v[16:19], v[84:87]
    v_mfma_f32_16x16x32_bf16 v[88:91], v[56:59], v[16:19], v[88:91]
    v_mfma_f32_16x16x32_bf16 v[92:95], v[60:63], v[16:19], v[92:95]
    s_cmp_eq_u32 s26, 1
    s_cselect_b32 s10, 0, s10
    v_xor_b32 v178, s25, v1
    s_waitcnt vmcnt(7)
    buffer_load_dwordx4 v[112:115], v178, s[8:11], 0 offen nt
    v_mfma_f32_16x16x32_bf16 v[96:99], v[64:67], v[16:19], v[96:99]
    v_mfma_f32_16x16x32_bf16 v[100:103], v[68:71], v[16:19], v[100:103]
    v_mfma_f32_16x16x32_bf16 v[104:107], v[72:75], v[16:19], v[104:107]
    v_mfma_f32_16x16x32_bf16 v[108:111], v[76:79], v[16:19], v[108:111]
    v_xor_b32 v180, 0x8b00, v178
    s_waitcnt vmcnt(7)
    buffer_load_dwordx4 v[116:119], v180, s[8:11], 0 offen nt
    v_perm_b32 v48, v148, v144, s29
    v_perm_b32 v52, v148, v144, s30
    v_perm_b32 v56, v149, v145, s29
    v_perm_b32 v60, v149, v145, s30
    v_perm_b32 v64, v150, v146, s29
    v_perm_b32 v68, v150, v146, s30
    v_perm_b32 v72, v151, v147, s29
    v_perm_b32 v76, v151, v147, s30
    v_xor_b32 v179, 0x12000, v178
    s_waitcnt vmcnt(7)
    buffer_load_dwordx4 v[120:123], v179, s[8:11], 0 offen nt
    v_mov_b32_dpp v12, v12 row_ror:8 row_mask:0xf bank_mask:0x3
    v_mov_b32_dpp v13, v13 row_ror:8 row_mask:0xf bank_mask:0x3
    v_mov_b32_dpp v14, v14 row_ror:8 row_mask:0xf bank_mask:0x3
    v_mov_b32_dpp v15, v15 row_ror:8 row_mask:0xf bank_mask:0x3
    s_add_u32 s31, s33, 1
    s_mov_b32 s25, s24
    s_bitcmp1_b32 s31, 0
    s_cselect_b32 s3, 0x11300, 0
    s_xor_b32 s25, s25, s3
    s_bitcmp1_b32 s31, 1
    s_cselect_b32 s3, 0xc9200, 0
    s_xor_b32 s25, s25, s3
    s_bitcmp1_b32 s31, 2
    s_cselect_b32 s3, 0x4b000, 0
    s_xor_b32 s25, s25, s3
    s_bitcmp1_b32 s31, 3
    s_cselect_b32 s3, 0x94100, 0
    s_xor_b32 s25, s25, s3
    s_bitcmp1_b32 s31, 4
    s_cselect_b32 s3, 0x43f00, 0
    s_xor_b32 s25, s25, s3
    v_xor_b32 v180, 0x1ab00, v178
    s_waitcnt vmcnt(7)
    buffer_load_dwordx4 v[124:127], v180, s[8:11], 0 offen nt
    v_perm_b32 v49, v156, v152, s29
    v_perm_b32 v53, v156, v152, s30
    v_perm_b32 v57, v157, v153, s29
    v_perm_b32 v61, v157, v153, s30
    v_perm_b32 v65, v158, v154, s29
    v_perm_b32 v69, v158, v154, s30
    v_perm_b32 v73, v159, v155, s29
    v_perm_b32 v77, v159, v155, s30
    v_xor_b32 v179, 0x72b00, v178
    s_waitcnt vmcnt(7)
    buffer_load_dwordx4 v[128:131], v179, s[8:11], 0 offen nt
    s_cmp_lg_u32 s26, 1
    s_cbranch_scc1 L_V8_l
    s_call_b64 s[58:59], L_sum
L_V8_l:
    s_sub_u32 s26, s26, 1
    s_cmp_lt_u32 s33, s51
    s_cselect_b32 s60, s52, 10
    s_xor_b32 s60, s60, 8
    s_cmp_eq_u32 s26, 0
    s_cselect_b32 s60, 1, s60
    s_cmp_eq_u32 s33, s50
    s_cselect_b32 s60, 1, s60
    v_xor_b32 v180, 0x7a000, v178
    s_waitcnt vmcnt(7)
    buffer_load_dwordx4 v[132:135], v180, s[8:11], 0 offen nt
    v_perm_b32 v50, v164, v160, s29
    v_perm_b32 v54, v164, v160, s30
    v_perm_b32 v58, v165, v161, s29
    v_perm_b32 v62, v165, v161, s30
    v_perm_b32 v66, v166, v162, s29
    v_perm_b32 v70, v166, v162, s30
    v_perm_b32 v74, v167, v163, s29
    v_perm_b32 v78, v167, v163, s30
    v_xor_b32 v179, 0x60b00, v178
    s_waitcnt vmcnt(7)
    buffer_load_dwordx4 v[136:139], v179, s[8:11], 0 offen nt
    s_waitcnt lgkmcnt(1)
    v_sub_f32 v24, v24, v5
    v_sub_f32 v25, v25, v5
    v_sub_f32 v26, v26, v5
    v_sub_f32 v27, v27, v5
    v_sub_f32 v28, v28, v5
    v_sub_f32 v29, v29, v5
    v_sub_f32 v30, v30, v5
    v_sub_f32 v31, v31, v5
    v_mul_f32 v24, s28, v24
    v_mul_f32 v25, s28, v25
    v_mul_f32 v26, s28, v26
    v_mul_f32 v27, s28, v27
    v_mul_f32 v28, s28, v28
    v_mul_f32 v29, s28, v29
    v_mul_f32 v30, s28, v30
    v_mul_f32 v31, s28, v31
    v_xor_b32 v180, 0x68000, v178
    s_waitcnt vmcnt(7)
    buffer_load_dwordx4 v[140:143], v180, s[8:11], 0 offen nt
    v_perm_b32 v51, v172, v168, s29
    v_perm_b32 v55, v172, v168, s30
    v_perm_b32 v59, v173, v169, s29
    v_perm_b32 v63, v173, v169, s30
    v_perm_b32 v67, v174, v170, s29
    v_perm_b32 v71, v174, v170, s30
    v_perm_b32 v75, v175, v171, s29
    v_perm_b32 v79, v175, v171, s30
    v_mfma_f32_16x16x32_bf16 v[80:83], v[48:51], v[12:15], v[80:83]
    v_mfma_f32_16x16x32_bf16 v[84:87], v[52:55], v[12:15], v[84:87]
    v_mfma_f32_16x16x32_bf16 v[88:91], v[56:59], v[12:15], v[88:91]
    v_mfma_f32_16x16x32_bf16 v[92:95], v[60:63], v[12:15], v[92:95]
    v_mfma_f32_16x16x32_bf16 v[96:99], v[64:67], v[12:15], v[96:99]
    v_mfma_f32_16x16x32_bf16 v[100:103], v[68:71], v[12:15], v[100:103]
    v_mfma_f32_16x16x32_bf16 v[104:107], v[72:75], v[12:15], v[104:107]
    v_mfma_f32_16x16x32_bf16 v[108:111], v[76:79], v[12:15], v[108:111]
    s_cmp_eq_u32 s60, 0
    s_cbranch_scc1 L_V8
    s_cmp_eq_u32 s26, 0
    s_cbranch_scc1 L_epi
    s_cmp_lg_u32 s33, s50
    s_cbranch_scc1 L_V8_c
    s_call_b64 s[58:59], L_ctl
L_V8_c:
    s_cmp_lt_u32 s33, s51
    s_cselect_b32 s32, s52, 10
    s_cmp_gt_u32 s32, 8
    s_cbranch_scc1 L_V8_up
    s_branch L_V8
L_V8_up:
    v_xor_b32 v179, 0x8800, v178
    buffer_load_dwordx4 v[144:147], v179, s[8:11], 0 offen nt
    s_branch L_V9
L_T10:
    v_subrev_u32 v7, 65536, v7
    ds_read_b128 v[24:27], v7
    ds_read_b128 v[28:31], v7 offset:1024
    ds_read_b32 v189, v7
    v_max_f32_dpp v5, v5, v5 row_ror:8 row_mask:0xf bank_mask:0xf
    s_mov_b32 s26, 32
    v_mov_b32 v4, v5
    s_nop 1
    v_permlane32_swap_b32 v5, v4
    v_max_f32 v5, v5, v4
    v_mov_b32 v4, v5
    s_nop 1
    v_permlane16_swap_b32 v5, v4
    v_max_f32 v5, v5, v4
    s_waitcnt lgkmcnt(1)
    v_sub_f32 v24, v24, v5
    v_sub_f32 v25, v25, v5
    v_sub_f32 v26, v26, v5
    v_sub_f32 v27, v27, v5
    v_sub_f32 v28, v28, v5
    v_sub_f32 v29, v29, v5
    v_sub_f32 v30, v30, v5
    v_sub_f32 v31, v31, v5
    v_mul_f32 v24, s28, v24
    v_mul_f32 v25, s28, v25
    v_mul_f32 v26, s28, v26
    v_mul_f32 v27, s28, v27
    v_mul_f32 v28, s28, v28
    v_mul_f32 v29, s28, v29
    v_mul_f32 v30, s28, v30
    v_mul_f32 v31, s28, v31
.p2align 3
L_V10:
    v_xor_b32 v179, 0x1a800, v178
    s_waitcnt vmcnt(9)
    buffer_load_dwordx4 v[152:155], v179, s[8:11], 0 offen nt
L_V10_a:
    v_xor_b32 v180, 0x12300, v178
    buffer_load_dwordx4 v[156:159], v180, s[8:11], 0 offen nt
    s_add_u32 s33, s33, 1
    v_exp_f32 v24, v24
    v_exp_f32 v25, v25
    v_exp_f32 v26, v26
    v_exp_f32 v27, v27
    v_exp_f32 v28, v28
    v_xor_b32 v179, 0x7a300, v178
    s_waitcnt vmcnt(10)
    buffer_load_dwordx4 v[160:163], v179, s[8:11], 0 offen nt
    v_perm_b32 v48, v116, v112, s29
    v_perm_b32 v52, v116, v112, s30
    v_perm_b32 v56, v117, v113, s29
    v_perm_b32 v60, v117, v113, s30
    v_perm_b32 v64, v118, v114, s29
    v_perm_b32 v68, v118, v114, s30
    v_perm_b32 v72, v119, v115, s29
    v_perm_b32 v76, v119, v115, s30
    v_xor_b32 v180, 0x72800, v178
    s_waitcnt vmcnt(10)
    buffer_load_dwordx4 v[164:167], v180, s[8:11], 0 offen nt
    v_exp_f32 v29, v29
    v_exp_f32 v30, v30
    v_exp_f32 v31, v31
    v_add_f32 v3, v24, v25
    v_add_f32 v4, v26, v27
    v_xor_b32 v179, 0x68300, v178
    s_waitcnt vmcnt(10)
    buffer_load_dwordx4 v[168:171], v179, s[8:11], 0 offen nt
    v_perm_b32 v49, v124, v120, s29
    v_perm_b32 v53, v124, v120, s30
    v_perm_b32 v57, v125, v121, s29
    v_perm_b32 v61, v125, v121, s30
    v_perm_b32 v65, v126, v122, s29
    v_perm_b32 v69, v126, v122, s30
    v_perm_b32 v73, v127, v123, s29
    v_perm_b32 v77, v127, v123, s30
    v_xor_b32 v180, 0x60800, v178
    s_waitcnt vmcnt(10)
    buffer_load_dwordx4 v[172:175], v180, s[8:11], 0 offen nt
    v_cvt_pk_bf16_f32 v16, v24, v25
    v_cvt_pk_bf16_f32 v17, v26, v27
    v_cvt_pk_bf16_f32 v18, v28, v29
    v_cvt_pk_bf16_f32 v19, v30, v31
    v_cvt_pk_bf16_f32 v12, v24, v25
    v_cvt_pk_bf16_f32 v13, v26, v27
    v_cvt_pk_bf16_f32 v14, v28, v29
    v_cvt_pk_bf16_f32 v15, v30, v31
    v_add_f32 v3, v3, v28
    v_add_f32 v4, v4, v29
    v_add_f32 v3, v3, v30
    v_add_f32 v4, v4, v31
    v_add_f32 v6, v6, v3
    v_add_f32 v6, v6, v4
    s_cmp_eq_u32 s26, 1
    s_cselect_b32 s10, 0, s10
    v_xor_b32 v178, s25, v1
    s_waitcnt vmcnt(10)
    buffer_load_dwordx4 v[112:115], v178, s[8:11], 0 offen nt
    v_perm_b32 v50, v132, v128, s29
    v_perm_b32 v54, v132, v128, s30
    v_perm_b32 v58, v133, v129, s29
    v_perm_b32 v62, v133, v129, s30
    v_perm_b32 v66, v134, v130, s29
    v_perm_b32 v70, v134, v130, s30
    v_perm_b32 v74, v135, v131, s29
    v_perm_b32 v78, v135, v131, s30
    s_waitcnt vmcnt(10)
    v_add_u32 v7, 2048, v7
    ds_read_b128 v[24:27], v7
    ds_read_b128 v[28:31], v7 offset:1024
    ds_read_b32 v189, v7
    v_mov_b32_dpp v16, v16 row_ror:8 row_mask:0xf bank_mask:0xc
    v_mov_b32_dpp v17, v17 row_ror:8 row_mask:0xf bank_mask:0xc
    v_mov_b32_dpp v18, v18 row_ror:8 row_mask:0xf bank_mask:0xc
    v_mov_b32_dpp v19, v19 row_ror:8 row_mask:0xf bank_mask:0xc
    v_xor_b32 v180, 0x8b00, v178
    s_waitcnt vmcnt(9)
    buffer_load_dwordx4 v[116:119], v180, s[8:11], 0 offen nt
    v_perm_b32 v51, v140, v136, s29
    v_perm_b32 v55, v140, v136, s30
    v_perm_b32 v59, v141, v137, s29
    v_perm_b32 v63, v141, v137, s30
    v_perm_b32 v67, v142, v138, s29
    v_perm_b32 v71, v142, v138, s30
    v_perm_b32 v75, v143, v139, s29
    v_perm_b32 v79, v143, v139, s30
    v_mfma_f32_16x16x32_bf16 v[80:83], v[48:51], v[16:19], v[80:83]
    v_mfma_f32_16x16x32_bf16 v[84:87], v[52:55], v[16:19], v[84:87]
    v_mfma_f32_16x16x32_bf16 v[88:91], v[56:59], v[16:19], v[88:91]
    v_mfma_f32_16x16x32_bf16 v[92:95], v[60:63], v[16:19], v[92:95]
    v_xor_b32 v179, 0x12000, v178
    s_waitcnt vmcnt(9)
    buffer_load_dwordx4 v[120:123], v179, s[8:11], 0 offen nt
    v_mfma_f32_16x16x32_bf16 v[96:99], v[64:67], v[16:19], v[96:99]
    v_mfma_f32_16x16x32_bf16 v[100:103], v[68:71], v[16:19], v[100:103]
    v_mfma_f32_16x16x32_bf16 v[104:107], v[72:75], v[16:19], v[104:107]
    v_mfma_f32_16x16x32_bf16 v[108:111], v[76:79], v[16:19], v[108:111]
    v_xor_b32 v180, 0x1ab00, v178
    s_waitcnt vmcnt(9)
    buffer_load_dwordx4 v[124:127], v180, s[8:11], 0 offen nt
    v_perm_b32 v48, v148, v144, s29
    v_perm_b32 v52, v148, v144, s30
    v_perm_b32 v56, v149, v145, s29
    v_perm_b32 v60, v149, v145, s30
    v_perm_b32 v64, v150, v146, s29
    v_perm_b32 v68, v150, v146, s30
    v_perm_b32 v72, v151, v147, s29
    v_perm_b32 v76, v151, v147, s30
    v_xor_b32 v179, 0x72b00, v178
    s_waitcnt vmcnt(9)
    buffer_load_dwordx4 v[128:131], v179, s[8:11], 0 offen nt
    v_mov_b32_dpp v12, v12 row_ror:8 row_mask:0xf bank_mask:0x3
    v_mov_b32_dpp v13, v13 row_ror:8 row_mask:0xf bank_mask:0x3
    v_mov_b32_dpp v14, v14 row_ror:8 row_mask:0xf bank_mask:0x3
    v_mov_b32_dpp v15, v15 row_ror:8 row_mask:0xf bank_mask:0x3
    s_add_u32 s31, s33, 1
    s_mov_b32 s25, s24
    s_bitcmp1_b32 s31, 0
    s_cselect_b32 s3, 0x11300, 0
    s_xor_b32 s25, s25, s3
    s_bitcmp1_b32 s31, 1
    s_cselect_b32 s3, 0xc9200, 0
    s_xor_b32 s25, s25, s3
    s_bitcmp1_b32 s31, 2
    s_cselect_b32 s3, 0x4b000, 0
    s_xor_b32 s25, s25, s3
    s_bitcmp1_b32 s31, 3
    s_cselect_b32 s3, 0x94100, 0
    s_xor_b32 s25, s25, s3
    s_bitcmp1_b32 s31, 4
    s_cselect_b32 s3, 0x43f00, 0
    s_xor_b32 s25, s25, s3
    v_xor_b32 v180, 0x7a000, v178
    s_waitcnt vmcnt(9)
    buffer_load_dwordx4 v[132:135], v180, s[8:11], 0 offen nt
    v_perm_b32 v49, v156, v152, s29
    v_perm_b32 v53, v156, v152, s30
    v_perm_b32 v57, v157, v153, s29
    v_perm_b32 v61, v157, v153, s30
    v_perm_b32 v65, v158, v154, s29
    v_perm_b32 v69, v158, v154, s30
    v_perm_b32 v73, v159, v155, s29
    v_perm_b32 v77, v159, v155, s30
    v_xor_b32 v179, 0x60b00, v178
    s_waitcnt vmcnt(9)
    buffer_load_dwordx4 v[136:139], v179, s[8:11], 0 offen nt
    s_cmp_lg_u32 s26, 1
    s_cbranch_scc1 L_V10_l
    s_call_b64 s[58:59], L_sum
L_V10_l:
    s_sub_u32 s26, s26, 1
    s_cmp_lt_u32 s33, s51
    s_cselect_b32 s60, s52, 10
    s_xor_b32 s60, s60, 10
    s_cmp_eq_u32 s26, 0
    s_cselect_b32 s60, 1, s60
    s_cmp_eq_u32 s33, s50
    s_cselect_b32 s60, 1, s60
    v_xor_b32 v180, 0x68000, v178
    s_waitcnt vmcnt(9)
    buffer_load_dwordx4 v[140:143], v180, s[8:11], 0 offen nt
    v_perm_b32 v50, v164, v160, s29
    v_perm_b32 v54, v164, v160, s30
    v_perm_b32 v58, v165, v161, s29
    v_perm_b32 v62, v165, v161, s30
    v_perm_b32 v66, v166, v162, s29
    v_perm_b32 v70, v166, v162, s30
    v_perm_b32 v74, v167, v163, s29
    v_perm_b32 v78, v167, v163, s30
    v_xor_b32 v179, 0x8800, v178
    s_waitcnt vmcnt(9)
    buffer_load_dwordx4 v[144:147], v179, s[8:11], 0 offen nt
    s_waitcnt lgkmcnt(1)
    v_sub_f32 v24, v24, v5
    v_sub_f32 v25, v25, v5
    v_sub_f32 v26, v26, v5
    v_sub_f32 v27, v27, v5
    v_sub_f32 v28, v28, v5
    v_sub_f32 v29, v29, v5
    v_sub_f32 v30, v30, v5
    v_sub_f32 v31, v31, v5
    v_mul_f32 v24, s28, v24
    v_mul_f32 v25, s28, v25
    v_mul_f32 v26, s28, v26
    v_mul_f32 v27, s28, v27
    v_mul_f32 v28, s28, v28
    v_mul_f32 v29, s28, v29
    v_mul_f32 v30, s28, v30
    v_mul_f32 v31, s28, v31
    v_xor_b32 v180, 0x300, v178
    s_waitcnt vmcnt(9)
    buffer_load_dwordx4 v[148:151], v180, s[8:11], 0 offen nt
    v_perm_b32 v51, v172, v168, s29
    v_perm_b32 v55, v172, v168, s30
    v_perm_b32 v59, v173, v169, s29
    v_perm_b32 v63, v173, v169, s30
    v_perm_b32 v67, v174, v170, s29
    v_perm_b32 v71, v174, v170, s30
    v_perm_b32 v75, v175, v171, s29
    v_perm_b32 v79, v175, v171, s30
    v_mfma_f32_16x16x32_bf16 v[80:83], v[48:51], v[12:15], v[80:83]
    v_mfma_f32_16x16x32_bf16 v[84:87], v[52:55], v[12:15], v[84:87]
    v_mfma_f32_16x16x32_bf16 v[88:91], v[56:59], v[12:15], v[88:91]
    v_mfma_f32_16x16x32_bf16 v[92:95], v[60:63], v[12:15], v[92:95]
    v_mfma_f32_16x16x32_bf16 v[96:99], v[64:67], v[12:15], v[96:99]
    v_mfma_f32_16x16x32_bf16 v[100:103], v[68:71], v[12:15], v[100:103]
    v_mfma_f32_16x16x32_bf16 v[104:107], v[72:75], v[12:15], v[104:107]
    v_mfma_f32_16x16x32_bf16 v[108:111], v[76:79], v[12:15], v[108:111]
    s_cmp_eq_u32 s60, 0
    s_cbranch_scc1 L_V10
    s_cmp_eq_u32 s26, 0
    s_cbranch_scc1 L_epi
    s_cmp_lg_u32 s33, s50
    s_cbranch_scc1 L_V10_c
    s_call_b64 s[58:59], L_ctl
L_V10_c:
    s_cmp_lt_u32 s33, s51
    s_cselect_b32 s32, s52, 10
    s_cmp_gt_u32 s32, 10
    s_cbranch_scc1 L_V10_up
    s_cmp_ge_u32 s32, 10
    s_cbranch_scc1 L_V10
    s_waitcnt vmcnt(9)
    s_branch L_V9_a
L_V10_up:
    v_xor_b32 v179, 0x1a800, v178
    buffer_load_dwordx4 v[152:155], v179, s[8:11], 0 offen nt
    s_branch L_V11
L_sum:
    v_add_f32 v6, v6, v191
    s_nop 1
    v_add_f32_dpp v6, v6, v6 row_ror:8 row_mask:0xf bank_mask:0xf
    v_mov_b32 v8, v5
    v_mov_b32 v4, v6
    s_nop 1
    v_permlane32_swap_b32 v6, v4
    v_add_f32 v6, v6, v4
    v_mov_b32 v4, v6
    s_nop 1
    v_permlane16_swap_b32 v6, v4
    v_add_f32 v9, v6, v4
    ds_write_b64 v182, v[8:9]
    s_setpc_b64 s[58:59]
L_epi:
    s_cmp_lg_u32 s27, 0
    s_cbranch_scc1 L_epi1
    v_cndmask_b32 v48, v82, v83, s[34:35]
    v_cndmask_b32 v49, v86, v87, s[34:35]
    v_cndmask_b32 v50, v90, v91, s[34:35]
    v_cndmask_b32 v51, v94, v95, s[34:35]
    v_add_f32 v48, v48, v200
    v_add_f32 v49, v49, v201
    v_add_f32 v50, v50, v202
    v_add_f32 v51, v51, v203
    ds_write_b128 v181, v[48:51] offset:0
    v_cndmask_b32 v52, v98, v99, s[34:35]
    v_cndmask_b32 v53, v102, v103, s[34:35]
    v_cndmask_b32 v54, v106, v107, s[34:35]
    v_cndmask_b32 v55, v110, v111, s[34:35]
    v_add_f32 v52, v52, v204
    v_add_f32 v53, v53, v205
    v_add_f32 v54, v54, v206
    v_add_f32 v55, v55, v207
    ds_write_b128 v181, v[52:55] offset:1024
    v_cndmask_b32 v56, v80, v81, s[34:35]
    v_cndmask_b32 v57, v84, v85, s[34:35]
    v_cndmask_b32 v58, v88, v89, s[34:35]
    v_cndmask_b32 v59, v92, v93, s[34:35]
    v_cndmask_b32 v60, v96, v97, s[34:35]
    v_cndmask_b32 v61, v100, v101, s[34:35]
    v_cndmask_b32 v62, v104, v105, s[34:35]
    v_cndmask_b32 v63, v108, v109, s[34:35]
    s_branch L_epi2
L_epi1:
    v_cndmask_b32 v48, v80, v81, s[34:35]
    v_cndmask_b32 v49, v84, v85, s[34:35]
    v_cndmask_b32 v50, v88, v89, s[34:35]
    v_cndmask_b32 v51, v92, v93, s[34:35]
    v_add_f32 v48, v48, v200
    v_add_f32 v49, v49, v201
    v_add_f32 v50, v50, v202
    v_add_f32 v51, v51, v203
    ds_write_b128 v181, v[48:51] offset:0
    v_cndmask_b32 v52, v96, v97, s[34:35]
    v_cndmask_b32 v53, v100, v101, s[34:35]
    v_cndmask_b32 v54, v104, v105, s[34:35]
    v_cndmask_b32 v55, v108, v109, s[34:35]
    v_add_f32 v52, v52, v204
    v_add_f32 v53, v53, v205
    v_add_f32 v54, v54, v206
    v_add_f32 v55, v55, v207
    ds_write_b128 v181, v[52:55] offset:1024
    v_cndmask_b32 v56, v82, v83, s[34:35]
    v_cndmask_b32 v57, v86, v87, s[34:35]
    v_cndmask_b32 v58, v90, v91, s[34:35]
    v_cndmask_b32 v59, v94, v95, s[34:35]
    v_cndmask_b32 v60, v98, v99, s[34:35]
    v_cndmask_b32 v61, v102, v103, s[34:35]
    v_cndmask_b32 v62, v106, v107, s[34:35]
    v_cndmask_b32 v63, v110, v111, s[34:35]
L_epi2:
    v_add_f32 v56, v56, v192
    v_add_f32 v57, v57, v193
    v_add_f32 v58, v58, v194
    v_add_f32 v59, v59, v195
    v_add_f32 v60, v60, v196
    v_add_f32 v61, v61, v197
    v_add_f32 v62, v62, v198
    v_add_f32 v63, v63, v199
    s_waitcnt lgkmcnt(0)
    s_barrier
    ds_read_b64 v[72:73], v183
    ds_read_b128 v[64:67], v184
    ds_read_b128 v[68:71], v184 offset:1024
    s_waitcnt lgkmcnt(2)
    v_max_f32 v4, v72, v8
    v_sub_f32 v72, v72, v4
    v_sub_f32 v8, v8, v4
    v_mul_f32 v72, s28, v72
    v_mul_f32 v8, s28, v8
    v_exp_f32 v72, v72
    v_exp_f32 v8, v8
    v_mul_f32 v6, v72, v73
    v_fmac_f32 v6, v8, v9
    v_rcp_f32 v6, v6
    s_nop 0
    v_mul_f32 v8, v8, v6
    v_mul_f32 v72, v72, v6
    v_mul_f32 v56, v8, v56
    v_mul_f32 v57, v8, v57
    v_mul_f32 v58, v8, v58
    v_mul_f32 v59, v8, v59
    v_mul_f32 v60, v8, v60
    v_mul_f32 v61, v8, v61
    v_mul_f32 v62, v8, v62
    v_mul_f32 v63, v8, v63
    s_waitcnt lgkmcnt(0)
    v_fmac_f32 v56, v72, v64
    v_fmac_f32 v57, v72, v65
    v_fmac_f32 v58, v72, v66
    v_fmac_f32 v59, v72, v67
    v_fmac_f32 v60, v72, v68
    v_fmac_f32 v61, v72, v69
    v_fmac_f32 v62, v72, v70
    v_fmac_f32 v63, v72, v71
    v_cvt_pk_bf16_f32 v24, v56, v57
    v_cvt_pk_bf16_f32 v25, v58, v59
    v_cvt_pk_bf16_f32 v26, v60, v61
    v_cvt_pk_bf16_f32 v27, v62, v63
    buffer_store_dwordx4 v[24:27], v188, s[20:23], 0 offen
L_end:
    s_endpgm
L_ctl:
    s_add_u32 s57, s57, 1
    s_cmp_lg_u32 s57, 1
    s_cbranch_scc1 L_ctl_0
    s_mov_b32 s50, 25
    s_mov_b32 s53, 1
    s_atomic_add s53, s[48:49], s82 glc
    s_setpc_b64 s[58:59]
L_ctl_0:
    s_cmp_lg_u32 s57, 2
    s_cbranch_scc1 L_ctl_1
    s_mov_b32 s50, 35
    s_waitcnt lgkmcnt(0)
    s_sub_u32 s53, s53, s83
    s_and_b32 s53, s53, 0xff
    s_cmp_ge_u32 s53, 4
    s_cselect_b32 s55, 32, 16
    s_mov_b32 s61, 6
    s_mov_b32 s51, 35
    s_branch L_ctl_set
L_ctl_1:
    s_cmp_lg_u32 s57, 3
    s_cbranch_scc1 L_ctl_2
    s_mov_b32 s50, 36
    s_mov_b32 s53, 1
    s_atomic_add s53, s[48:49], s84 glc
    s_setpc_b64 s[58:59]
L_ctl_2:
    s_cmp_lg_u32 s57, 4
    s_cbranch_scc1 L_ctl_3
    s_mov_b32 s50, 48
    s_waitcnt lgkmcnt(0)
    s_sub_u32 s53, s53, s85
    s_and_b32 s53, s53, 0xff
    s_cmp_ge_u32 s53, 4
    s_cselect_b32 s55, 32, 16
    s_mov_b32 s61, 12
    s_mov_b32 s51, 50
    s_branch L_ctl_set
L_ctl_3:
    s_cmp_lg_u32 s57, 5
    s_cbranch_scc1 L_ctl_4
    s_mov_b32 s50, 50
    s_branch L_half
L_ctl_4:
    s_cmp_lg_u32 s57, 6
    s_cbranch_scc1 L_ctl_5
    s_mov_b32 s50, 51
    s_mov_b32 s53, 1
    s_atomic_add s53, s[48:49], s86 glc
    s_setpc_b64 s[58:59]
L_ctl_5:
    s_cmp_lg_u32 s57, 7
    s_cbranch_scc1 L_ctl_6
    s_mov_b32 s50, 57
    s_waitcnt lgkmcnt(0)
    s_sub_u32 s53, s53, s87
    s_and_b32 s53, s53, 0xff
    s_cmp_ge_u32 s53, 4
    s_cselect_b32 s55, 24, 12
    s_mov_b32 s61, 5
    s_mov_b32 s51, 57
    s_branch L_ctl_set
L_ctl_6:
    s_cmp_lg_u32 s57, 8
    s_cbranch_scc1 L_ctl_7
    s_mov_b32 s50, 58
    s_mov_b32 s53, 1
    s_atomic_add s53, s[48:49], s88 glc
    s_setpc_b64 s[58:59]
L_ctl_7:
    s_cmp_lg_u32 s57, 9
    s_cbranch_scc1 L_ctl_8
    s_mov_b32 s50, 255
    s_waitcnt lgkmcnt(0)
    s_sub_u32 s53, s53, s89
    s_and_b32 s53, s53, 0xff
    s_cmp_ge_u32 s53, 4
    s_cselect_b32 s55, 24, 12
    s_mov_b32 s61, 5
    s_mov_b32 s51, 63
    s_branch L_ctl_set
L_ctl_8:
    s_setpc_b64 s[58:59]
L_ctl_set:
    s_min_u32 s53, s53, 7
    s_sub_i32 s54, 3, s53
    s_sub_i32 s56, s53, 4
    s_max_i32 s56, s56, s54
    s_lshl_b32 s56, s56, 3
    s_mov_b32 s31, 0x1c0f0803
    s_lshr_b32 s56, s31, s56
    s_and_b32 s56, s56, 0xff
    s_mul_i32 s56, s56, s55
    s_cmp_ge_u32 s53, 4
    s_cselect_b32 s54, 1, -1
    s_add_u32 s56, s56, 32
    s_lshr_b32 s56, s56, 6
    s_cmp_gt_u32 s56, s61
    s_cselect_b32 s31, 1, 0
    s_lshr_b32 s56, s56, s31
    s_lshl_b32 s54, s54, s31
    s_add_i32 s52, s54, 10
    s_add_u32 s56, s56, s33
    s_min_u32 s51, s51, s56
    s_setpc_b64 s[58:59]
L_half:
    s_cmp_lg_u32 s27, 0
    s_cbranch_scc1 L_half1
    v_cndmask_b32 v200, v82, v83, s[34:35]
    v_cndmask_b32 v192, v80, v81, s[34:35]
    v_cndmask_b32 v201, v86, v87, s[34:35]
    v_cndmask_b32 v193, v84, v85, s[34:35]
    v_cndmask_b32 v202, v90, v91, s[34:35]
    v_cndmask_b32 v194, v88, v89, s[34:35]
    v_cndmask_b32 v203, v94, v95, s[34:35]
    v_cndmask_b32 v195, v92, v93, s[34:35]
    v_cndmask_b32 v204, v98, v99, s[34:35]
    v_cndmask_b32 v196, v96, v97, s[34:35]
    v_cndmask_b32 v205, v102, v103, s[34:35]
    v_cndmask_b32 v197, v100, v101, s[34:35]
    v_cndmask_b32 v206, v106, v107, s[34:35]
    v_cndmask_b32 v198, v104, v105, s[34:35]
    v_cndmask_b32 v207, v110, v111, s[34:35]
    v_cndmask_b32 v199, v108, v109, s[34:35]
    s_branch L_half2
L_half1:
    v_cndmask_b32 v200, v80, v81, s[34:35]
    v_cndmask_b32 v192, v82, v83, s[34:35]
    v_cndmask_b32 v201, v84, v85, s[34:35]
    v_cndmask_b32 v193, v86, v87, s[34:35]
    v_cndmask_b32 v202, v88, v89, s[34:35]
    v_cndmask_b32 v194, v90, v91, s[34:35]
    v_cndmask_b32 v203, v92, v93, s[34:35]
    v_cndmask_b32 v195, v94, v95, s[34:35]
    v_cndmask_b32 v204, v96, v97, s[34:35]
    v_cndmask_b32 v196, v98, v99, s[34:35]
    v_cndmask_b32 v205, v100, v101, s[34:35]
    v_cndmask_b32 v197, v102, v103, s[34:35]
    v_cndmask_b32 v206, v104, v105, s[34:35]
    v_cndmask_b32 v198, v106, v107, s[34:35]
    v_cndmask_b32 v207, v108, v109, s[34:35]
    v_cndmask_b32 v199, v110, v111, s[34:35]
L_half2:
    v_mov_b32 v191, v6
    v_mov_b32 v6, 0
    v_mov_b32 v80, 0
    v_mov_b32 v81, 0
    v_mov_b32 v82, 0
    v_mov_b32 v83, 0
    v_mov_b32 v84, 0
    v_mov_b32 v85, 0
    v_mov_b32 v86, 0
    v_mov_b32 v87, 0
    v_mov_b32 v88, 0
    v_mov_b32 v89, 0
    v_mov_b32 v90, 0
    v_mov_b32 v91, 0
    v_mov_b32 v92, 0
    v_mov_b32 v93, 0
    v_mov_b32 v94, 0
    v_mov_b32 v95, 0
    v_mov_b32 v96, 0
    v_mov_b32 v97, 0
    v_mov_b32 v98, 0
    v_mov_b32 v99, 0
    v_mov_b32 v100, 0
    v_mov_b32 v101, 0
    v_mov_b32 v102, 0
    v_mov_b32 v103, 0
    v_mov_b32 v104, 0
    v_mov_b32 v105, 0
    v_mov_b32 v106, 0
    v_mov_b32 v107, 0
    v_mov_b32 v108, 0
    v_mov_b32 v109, 0
    v_mov_b32 v110, 0
    v_mov_b32 v111, 0
    s_setpc_b64 s[58:59]
L_last:
    s_endpgm
.section .rodata,"a"
.p2align 6
.amdhsa_kernel standalone__gqa_softmax__sampling_kernel
  .amdhsa_next_free_vgpr 208
  .amdhsa_next_free_sgpr 90
  .amdhsa_accum_offset 208
  .amdhsa_group_segment_fixed_size 0
  .amdhsa_kernarg_size 48
  .amdhsa_user_sgpr_count 2
  .amdhsa_user_sgpr_kernarg_segment_ptr 1
  .amdhsa_system_sgpr_workgroup_id_x 1
.end_amdhsa_kernel
```
